```python
import torch

def _softmax(x, axis=-1):
    return torch.softmax(x, dim=axis)
def _gelu(x):
    return torch.nn.functional.gelu(x, approximate="tanh")
def _silu(x):
    return torch.nn.functional.silu(x)
def _sigmoid(x):
    return torch.sigmoid(x)
def _layernorm(x, axis=-1, eps=1e-5):
    m = x.mean(dim=axis, keepdim=True)
    v = x.var(dim=axis, keepdim=True, unbiased=False)
    return (x - m) / torch.sqrt(v + eps)
def _scatter_add(tgt, idx, src, axis=0):
    return tgt.clone().index_add_(axis, idx, src)
def _segment_sum(src, seg, n):
    out = torch.zeros((n,) + src.shape[1:], dtype=src.dtype)
    return out.index_add_(0, seg, src)
def _pad(x, pw):
    flat = tuple(v for pair in reversed(pw) for v in pair)
    return torch.nn.functional.pad(x, flat)

kernel_name = 'gated_mix__gqa_block_cached__gqa_block_cached__decode'

def setup_inputs():

    _w = (lambda a: (lambda t: t.to(torch.bfloat16) if t.is_floating_point() else t)(torch.as_tensor(a)))
    def _A_setup():
        B, Sq, D = 4, 1, 1024
        Hq, Hkv, Sk, Dh = 32, 4, 8192, 128
        assert Hq % Hkv == 0, (Hq, Hkv)
        return {
            "x": _w((lambda *s: torch.randn(*s, dtype=torch.bfloat16) * 0.05)(B, Sq, D)),
            "k_cache": _w((lambda *s: torch.randn(*s, dtype=torch.bfloat16) * 6.4)(B, Hkv, Sk, Dh)),
            "v_cache": _w((lambda *s: torch.randn(*s, dtype=torch.bfloat16) * 0.05)(B, Hkv, Sk, Dh)),
            "wq": _w((lambda *s: torch.randn(*s, dtype=torch.bfloat16) * 6.4)(D, Hq * Dh) * (D ** -0.5)),
            "wo": _w((lambda *s: torch.randn(*s, dtype=torch.bfloat16) * 0.05)(Hq * Dh, D) * ((Hq * Dh) ** -0.5)),
        }
    _A_in = _A_setup()

    def _B_setup():
        B, Sq, D = 4, 1, 1024
        Hq, Hkv, Sk, Dh = 32, 4, 8192, 128
        assert Hq % Hkv == 0, (Hq, Hkv)
        return {
            "x": _w((lambda *s: torch.randn(*s, dtype=torch.bfloat16) * 0.05)(B, Sq, D)),
            "k_cache": _w((lambda *s: torch.randn(*s, dtype=torch.bfloat16) * 6.4)(B, Hkv, Sk, Dh)),
            "v_cache": _w((lambda *s: torch.randn(*s, dtype=torch.bfloat16) * 0.05)(B, Hkv, Sk, Dh)),
            "wq": _w((lambda *s: torch.randn(*s, dtype=torch.bfloat16) * 6.4)(D, Hq * Dh) * (D ** -0.5)),
            "wo": _w((lambda *s: torch.randn(*s, dtype=torch.bfloat16) * 0.05)(Hq * Dh, D) * ((Hq * Dh) ** -0.5)),
        }
    _B_in = _B_setup()

    return {
        "A_x": _A_in["x"],
        "A_k_cache": _A_in["k_cache"],
        "A_v_cache": _A_in["v_cache"],
        "A_wq": _A_in["wq"],
        "A_wo": _A_in["wo"],
        "B_x": _B_in["x"],
        "B_k_cache": _B_in["k_cache"],
        "B_v_cache": _B_in["v_cache"],
        "B_wq": _B_in["wq"],
        "B_wo": _B_in["wo"],
        "gate_w": _w((lambda *s: torch.randn(*s, dtype=torch.bfloat16) * 0.05)(1024) * 16.0),
    }

def reference(A_x, A_k_cache, A_v_cache, A_wq, A_wo, B_x, B_k_cache, B_v_cache, B_wq, B_wo, gate_w):
    def _A_ref(x, k_cache, v_cache, wq, wo):
        B, Sq, D = x.shape
        Hq, Dh = 32, 128
        Hkv = k_cache.shape[1]
        rep = Hq // Hkv
        q = (lambda x, *d: x.permute(*d))((x @ wq).reshape(B, Sq, Hq, Dh), 0, 2, 1, 3)
        k = (lambda x, n, axis: torch.repeat_interleave(x, n, dim=axis))(k_cache, rep, axis=1)
        v = (lambda x, n, axis: torch.repeat_interleave(x, n, dim=axis))(v_cache, rep, axis=1)
        scores = torch.einsum("bhqd,bhkd->bhqk", q, k) * (Dh ** -0.5)
        p = _softmax(scores, axis=-1)
        o = torch.einsum("bhqk,bhkd->bhqd", p, v)
        return (lambda x, *d: x.permute(*d))(o, 0, 2, 1, 3).reshape(B, Sq, Hq * Dh) @ wo

    def _B_ref(x, k_cache, v_cache, wq, wo):
        B, Sq, D = x.shape
        Hq, Dh = 32, 128
        Hkv = k_cache.shape[1]
        rep = Hq // Hkv
        q = (lambda x, *d: x.permute(*d))((x @ wq).reshape(B, Sq, Hq, Dh), 0, 2, 1, 3)
        k = (lambda x, n, axis: torch.repeat_interleave(x, n, dim=axis))(k_cache, rep, axis=1)
        v = (lambda x, n, axis: torch.repeat_interleave(x, n, dim=axis))(v_cache, rep, axis=1)
        scores = torch.einsum("bhqd,bhkd->bhqk", q, k) * (Dh ** -0.5)
        p = _softmax(scores, axis=-1)
        o = torch.einsum("bhqk,bhkd->bhqd", p, v)
        return (lambda x, *d: x.permute(*d))(o, 0, 2, 1, 3).reshape(B, Sq, Hq * Dh) @ wo

    x = A_x
    g = _sigmoid((x * gate_w).sum(-1, keepdims=True))
    a = _A_ref(x, A_k_cache, A_v_cache, A_wq, A_wo)
    b = _B_ref(x, B_k_cache, B_v_cache, B_wq, B_wo)
    return g * a + (1 - g) * b
```

```asm
; @launch grid=(256,1,1) block=(256,1,1) lds=163840
.amdgcn_target "amdgcn-amd-amdhsa--gfx950"
.text
.globl gated_mix__gqa_block_cached__gqa_block_cached__decode_kernel
.p2align 8
.type gated_mix__gqa_block_cached__gqa_block_cached__decode_kernel,@function
gated_mix__gqa_block_cached__gqa_block_cached__decode_kernel:
    s_cmp_ge_u32 s2, 256
    s_cbranch_scc1 L_end
    s_load_dwordx16 s[4:19], s[0:1], 0
    s_load_dwordx8 s[20:27], s[0:1], 64
    s_load_dwordx4 s[28:31], s[0:1], 96
    v_lshrrev_b32 v26, 6, v0
    v_and_b32 v1, 63, v0
    v_readfirstlane_b32 s32, v26
    v_mov_b32 v222, 0
    v_mov_b32 v223, 1
    v_lshlrev_b32 v28, 2, v1
    v_and_b32 v28, 60, v28
    ds_write_b32 v28, v222 offset:28672
    s_and_b32 s33, s2, 7
    s_lshr_b32 s34, s2, 3
    s_mul_i32 s35, s33, 4
    s_add_u32 s35, s35, s34
    s_and_b32 s35, s35, 31
    s_mov_b32 s36, s33
    s_lshr_b32 s37, s35, 4
    s_and_b32 s38, s35, 15
    s_add_u32 s39, s34, s33
    s_and_b32 s39, s39, 7
    s_mov_b32 s74, s33
    s_lshr_b32 s75, s34, 2
    s_and_b32 s76, s39, 3
    s_lshl_b32 s58, s32, 14
    s_add_u32 s58, s58, 32768
    v_and_b32 v26, 15, v1
    v_lshrrev_b32 v27, 4, v1
    v_add_u32 v28, 0, v27
    v_lshlrev_b32 v28, 1, v28
    v_xor_b32 v28, v28, v26
    v_lshlrev_b32 v28, 4, v28
    v_lshl_add_u32 v8, v27, 13, v28
    v_lshl_add_u32 v6, v27, 8, v28
    v_add_u32 v28, 4, v27
    v_lshlrev_b32 v28, 1, v28
    v_xor_b32 v28, v28, v26
    v_lshlrev_b32 v28, 4, v28
    v_lshl_add_u32 v9, v27, 13, v28
    v_lshl_add_u32 v7, v27, 8, v28
    v_and_b32 v28, 3, v1
    v_lshlrev_b32 v28, 11, v28
    v_lshl_add_u32 v217, v27, 3, v28
    s_lshr_b32 s57, s34, 3
    s_lshl_b32 s61, s57, 9
    s_lshl_b32 s77, s32, 5
    s_add_u32 s61, s61, s77
    v_add_u32 v217, s61, v217
    s_lshl_b32 s59, s61, 12
    s_and_b32 s77, s33, 3
    s_lshl_b32 s77, s77, 11
    s_add_u32 s59, s59, s77
    s_lshl_b32 s77, s39, 8
    s_add_u32 s59, s59, s77
    s_mov_b32 s50, 8388608
    s_mov_b32 s51, 0x20000
    s_cmp_lt_u32 s33, 4
    s_waitcnt lgkmcnt(0)
    s_cselect_b32 s48, s10, s20
    s_cselect_b32 s49, s11, s21
    s_cselect_b32 s52, s12, s22
    s_cselect_b32 s53, s13, s23
    s_add_u32 m0, s58, 0
    s_add_u32 s62, s59, 0
    buffer_load_dwordx4 v8, s[48:51], s62 offen nt lds
    s_add_u32 m0, s58, 1024
    s_add_u32 s62, s59, 32768
    buffer_load_dwordx4 v9, s[48:51], s62 offen nt lds
    s_add_u32 m0, s58, 2048
    s_add_u32 s62, s59, 65536
    buffer_load_dwordx4 v8, s[48:51], s62 offen nt lds
    s_add_u32 m0, s58, 3072
    s_add_u32 s62, s59, 98304
    buffer_load_dwordx4 v9, s[48:51], s62 offen nt lds
    s_add_u32 m0, s58, 4096
    s_add_u32 s62, s59, 524288
    buffer_load_dwordx4 v8, s[48:51], s62 offen nt lds
    s_add_u32 m0, s58, 5120
    s_add_u32 s62, s59, 557056
    buffer_load_dwordx4 v9, s[48:51], s62 offen nt lds
    s_add_u32 m0, s58, 6144
    s_add_u32 s62, s59, 589824
    buffer_load_dwordx4 v8, s[48:51], s62 offen nt lds
    s_add_u32 m0, s58, 7168
    s_add_u32 s62, s59, 622592
    buffer_load_dwordx4 v9, s[48:51], s62 offen nt lds
    s_lshl_b32 s69, s33, 3
    s_add_u32 s69, s69, s39
    s_lshl_b32 s69, s69, 2
    s_add_u32 s69, s69, s57
    s_lshl_b32 s69, s69, 10
    s_add_u32 s69, s69, 65536
    s_lshl_b32 s77, s35, 14
    s_lshl_b32 s78, s36, 8
    s_add_u32 s77, s77, s78
    s_add_u32 s77, s77, 1048576
    v_lshrrev_b32 v28, 5, v0
    v_and_b32 v29, 31, v0
    v_lshlrev_b32 v30, 11, v28
    v_lshl_add_u32 v30, v29, 3, v30
    v_add_u32 v232, s77, v30
    v_mul_u32_u24 v230, 528, v28
    v_lshl_add_u32 v230, v29, 4, v230
    s_lshl_b32 s61, s74, 3
    s_add_u32 s61, s61, s75
    s_lshl_b32 s61, s61, 2
    s_add_u32 s61, s61, s76
    s_lshl_b32 s61, s61, 12
    s_add_u32 s61, s61, 3145728
    v_lshlrev_b32 v219, 4, v0
    v_add_u32 v219, s61, v219
    v_mov_b32 v224, -1
    v_mov_b32 v225, -1
    v_mov_b32 v226, -1
    v_mov_b32 v227, -1
    s_cmp_gt_u32 s32, 0
    s_cbranch_scc1 L_clr1
    v_lshlrev_b32 v218, 4, v1
    v_add_u32 v218, s69, v218
    global_store_dwordx4 v218, v[224:227], s[30:31] sc1
    s_branch L_clrdone
L_clr1:
    s_cmp_gt_u32 s32, 1
    s_cbranch_scc1 L_clr2
    s_lshl_b32 s77, s35, 8
    s_lshl_b32 s78, s36, 2
    s_add_u32 s77, s77, s78
    s_add_u32 s77, s77, 2097152
    v_lshlrev_b32 v218, 5, v1
    v_add_u32 v218, s77, v218
    s_mov_b64 exec, 0xff
    global_store_dword v218, v224, s[30:31] sc1
    s_branch L_clrdone
L_clr2:
    s_add_u32 s77, s32, s36
    s_cmp_lg_u32 s77, 2
    s_cbranch_scc1 L_clrdone
    s_lshl_b32 s77, s35, 8
    v_mov_b32 v220, s77
    s_mov_b64 exec, 1
    global_store_dword v220, v222, s[30:31] sc1
L_clrdone:
    s_mov_b64 exec, -1
    v_mov_b32 v221, v219
    global_store_dwordx2 v232, v[224:225], s[30:31] sc1
    global_store_dwordx4 v221, v[224:227], s[30:31] sc1
    global_load_dwordx2 v[176:177], v217, s[4:5] offset:0
    global_load_dwordx2 v[178:179], v217, s[4:5] offset:128
    global_load_dwordx2 v[180:181], v217, s[4:5] offset:256
    global_load_dwordx2 v[182:183], v217, s[4:5] offset:384
    s_barrier
    s_add_u32 m0, s58, 8192
    s_add_u32 s62, s59, 1048576
    buffer_load_dwordx4 v8, s[48:51], s62 offen nt lds
    s_add_u32 m0, s58, 9216
    s_add_u32 s62, s59, 1081344
    buffer_load_dwordx4 v9, s[48:51], s62 offen nt lds
    s_add_u32 m0, s58, 10240
    s_add_u32 s62, s59, 1114112
    buffer_load_dwordx4 v8, s[48:51], s62 offen nt lds
    s_add_u32 m0, s58, 11264
    s_add_u32 s62, s59, 1146880
    buffer_load_dwordx4 v9, s[48:51], s62 offen nt lds
    s_add_u32 m0, s58, 12288
    s_add_u32 s62, s59, 1572864
    buffer_load_dwordx4 v8, s[48:51], s62 offen nt lds
    s_add_u32 m0, s58, 13312
    s_add_u32 s62, s59, 1605632
    buffer_load_dwordx4 v9, s[48:51], s62 offen nt lds
    s_add_u32 m0, s58, 14336
    s_add_u32 s62, s59, 1638400
    buffer_load_dwordx4 v8, s[48:51], s62 offen nt lds
    s_add_u32 m0, s58, 15360
    s_add_u32 s62, s59, 1671168
    buffer_load_dwordx4 v9, s[48:51], s62 offen nt lds
    s_mov_b32 s68, 0x3e0293ee
    s_mov_b32 s72, 0xffff0000
    s_mov_b32 s54, 8388608
    s_mov_b32 s55, 0x20000
    s_cmp_eq_u32 s37, 0
    s_cselect_b32 s40, s6, s16
    s_cselect_b32 s41, s7, s17
    s_cselect_b32 s44, s8, s18
    s_cselect_b32 s45, s9, s19
    s_mov_b32 s42, 33554432
    s_mov_b32 s43, 0x20000
    s_mov_b32 s46, 33554432
    s_mov_b32 s47, 0x20000
    s_lshl_b32 s63, s38, 21
    s_lshl_b32 s77, s36, 2
    s_add_u32 s77, s77, s32
    s_mul_i32 s3, s35, 16
    s_add_u32 s56, s77, s3
    s_add_u32 s3, s3, 192
    s_mov_b32 s66, 0
    s_mov_b32 s79, 0
    s_mov_b32 s19, 0
    s_mov_b32 s20, 0
    s_lshl_b32 s78, s32, 10
    s_add_u32 s61, s61, s78
    v_lshlrev_b32 v236, 6, v26
    v_lshl_add_u32 v236, v27, 4, v236
    v_add_u32 v236, s61, v236
    v_add_u32 v28, 0, v27
    v_xor_b32 v28, v28, v26
    v_lshlrev_b32 v28, 4, v28
    v_lshl_add_u32 v2, v27, 8, v28
    v_add_u32 v28, 4, v27
    v_xor_b32 v28, v28, v26
    v_lshlrev_b32 v28, 4, v28
    v_lshl_add_u32 v3, v27, 8, v28
    v_add_u32 v28, 8, v27
    v_xor_b32 v28, v28, v26
    v_lshlrev_b32 v28, 4, v28
    v_lshl_add_u32 v4, v27, 8, v28
    v_add_u32 v28, 12, v27
    v_xor_b32 v28, v28, v26
    v_lshlrev_b32 v28, 4, v28
    v_lshl_add_u32 v5, v27, 8, v28
    v_lshrrev_b32 v28, 2, v1
    v_and_b32 v29, 7, v28
    v_and_b32 v30, 3, v1
    v_lshlrev_b32 v30, 3, v30
    v_lshl_add_u32 v30, v28, 8, v30
    v_add_u32 v30, s58, v30
    v_xor_b32 v31, 0, v29
    v_lshl_add_u32 v18, v31, 5, v30
    v_xor_b32 v31, 1, v29
    v_lshl_add_u32 v19, v31, 5, v30
    v_xor_b32 v31, 2, v29
    v_lshl_add_u32 v20, v31, 5, v30
    v_xor_b32 v31, 3, v29
    v_lshl_add_u32 v21, v31, 5, v30
    v_xor_b32 v31, 4, v29
    v_lshl_add_u32 v22, v31, 5, v30
    v_xor_b32 v31, 5, v29
    v_lshl_add_u32 v23, v31, 5, v30
    v_xor_b32 v31, 6, v29
    v_lshl_add_u32 v24, v31, 5, v30
    v_xor_b32 v31, 7, v29
    v_lshl_add_u32 v25, v31, 5, v30
    v_add_u32 v28, 0, v27
    v_xor_b32 v28, v28, v26
    v_lshlrev_b32 v28, 4, v28
    v_lshl_add_u32 v28, v26, 8, v28
    v_add_u32 v14, s58, v28
    v_add_u32 v28, 4, v27
    v_xor_b32 v28, v28, v26
    v_lshlrev_b32 v28, 4, v28
    v_lshl_add_u32 v28, v26, 8, v28
    v_add_u32 v15, s58, v28
    v_add_u32 v28, 8, v27
    v_xor_b32 v28, v28, v26
    v_lshlrev_b32 v28, 4, v28
    v_lshl_add_u32 v28, v26, 8, v28
    v_add_u32 v16, s58, v28
    v_add_u32 v28, 12, v27
    v_xor_b32 v28, v28, v26
    v_lshlrev_b32 v28, 4, v28
    v_lshl_add_u32 v28, v26, 8, v28
    v_add_u32 v17, s58, v28
    v_cmp_gt_u32 s[14:15], 8, v26
    v_cmp_gt_u32 s[16:17], 4, v26
    v_mul_u32_u24 v218, 528, v26
    v_lshl_add_u32 v218, v27, 4, v218
    s_mul_i32 s77, s32, 4224
    v_add_u32 v228, s77, v218
    s_mul_i32 s77, s32, 2112
    v_add_u32 v218, s77, v218
    s_mov_b64 exec, 1
    s_waitcnt vmcnt(12)
    ds_add_rtn_u32 v28, v222, v223 offset:28680
    s_waitcnt lgkmcnt(0)
    v_readfirstlane_b32 s77, v28
    s_cmp_lg_u32 s77, 3
    s_cbranch_scc1 L_noflag
    s_and_b32 s77, s2, 63
    s_lshl_b32 s77, s77, 2
    v_mov_b32 v28, s77
    global_atomic_add v28, v223, s[28:29] sc1
L_noflag:
    s_mov_b64 exec, -1
    s_waitcnt vmcnt(8)
    ds_read_b64_tr_b16 v[156:157], v18 offset:0
    ds_read_b64_tr_b16 v[158:159], v19 offset:0
    ds_read_b64_tr_b16 v[160:161], v20 offset:0
    ds_read_b64_tr_b16 v[162:163], v21 offset:0
    ds_read_b64_tr_b16 v[164:165], v22 offset:0
    ds_read_b64_tr_b16 v[166:167], v23 offset:0
    ds_read_b64_tr_b16 v[168:169], v24 offset:0
    ds_read_b64_tr_b16 v[170:171], v25 offset:0
    s_waitcnt lgkmcnt(0)
    s_add_u32 s65, s56, 0
    s_and_b32 s65, s65, 511
    s_lshl_b32 s65, s65, 12
    s_add_u32 s65, s65, s63
    s_add_u32 m0, s58, 0
    s_add_u32 s62, s65, 0
    buffer_load_dwordx4 v2, s[40:43], s62 offen offset:0 nt lds
    buffer_load_dwordx4 v3, s[40:43], s62 offen offset:1024 nt lds
    buffer_load_dwordx4 v4, s[40:43], s62 offen offset:2048 nt lds
    buffer_load_dwordx4 v5, s[40:43], s62 offen offset:3072 nt lds
    v_mfma_f32_16x16x16_bf16 v[48:51], v[156:157], v[176:177], 0
    v_mfma_f32_16x16x16_bf16 v[52:55], v[158:159], v[176:177], 0
    v_mfma_f32_16x16x16_bf16 v[56:59], v[160:161], v[176:177], 0
    v_mfma_f32_16x16x16_bf16 v[60:63], v[162:163], v[176:177], 0
    v_mfma_f32_16x16x16_bf16 v[64:67], v[164:165], v[176:177], 0
    v_mfma_f32_16x16x16_bf16 v[68:71], v[166:167], v[176:177], 0
    v_mfma_f32_16x16x16_bf16 v[72:75], v[168:169], v[176:177], 0
    v_mfma_f32_16x16x16_bf16 v[76:79], v[170:171], v[176:177], 0
    ds_read_b64_tr_b16 v[156:157], v18 offset:4096
    ds_read_b64_tr_b16 v[158:159], v19 offset:4096
    ds_read_b64_tr_b16 v[160:161], v20 offset:4096
    ds_read_b64_tr_b16 v[162:163], v21 offset:4096
    ds_read_b64_tr_b16 v[164:165], v22 offset:4096
    ds_read_b64_tr_b16 v[166:167], v23 offset:4096
    ds_read_b64_tr_b16 v[168:169], v24 offset:4096
    ds_read_b64_tr_b16 v[170:171], v25 offset:4096
    s_waitcnt lgkmcnt(0)
    s_add_u32 m0, s58, 4096
    s_add_u32 s62, s65, 0
    buffer_load_dwordx4 v6, s[44:47], s62 offen offset:0 nt lds
    buffer_load_dwordx4 v7, s[44:47], s62 offen offset:1024 nt lds
    buffer_load_dwordx4 v6, s[44:47], s62 offen offset:2048 nt lds
    buffer_load_dwordx4 v7, s[44:47], s62 offen offset:3072 nt lds
    v_mfma_f32_16x16x16_bf16 v[48:51], v[156:157], v[178:179], v[48:51]
    v_mfma_f32_16x16x16_bf16 v[52:55], v[158:159], v[178:179], v[52:55]
    v_mfma_f32_16x16x16_bf16 v[56:59], v[160:161], v[178:179], v[56:59]
    v_mfma_f32_16x16x16_bf16 v[60:63], v[162:163], v[178:179], v[60:63]
    v_mfma_f32_16x16x16_bf16 v[64:67], v[164:165], v[178:179], v[64:67]
    v_mfma_f32_16x16x16_bf16 v[68:71], v[166:167], v[178:179], v[68:71]
    v_mfma_f32_16x16x16_bf16 v[72:75], v[168:169], v[178:179], v[72:75]
    v_mfma_f32_16x16x16_bf16 v[76:79], v[170:171], v[178:179], v[76:79]
    s_waitcnt vmcnt(12)
    ds_read_b64_tr_b16 v[156:157], v18 offset:8192
    ds_read_b64_tr_b16 v[158:159], v19 offset:8192
    ds_read_b64_tr_b16 v[160:161], v20 offset:8192
    ds_read_b64_tr_b16 v[162:163], v21 offset:8192
    ds_read_b64_tr_b16 v[164:165], v22 offset:8192
    ds_read_b64_tr_b16 v[166:167], v23 offset:8192
    ds_read_b64_tr_b16 v[168:169], v24 offset:8192
    ds_read_b64_tr_b16 v[170:171], v25 offset:8192
    s_waitcnt lgkmcnt(0)
    s_add_u32 s65, s56, 32
    s_and_b32 s65, s65, 511
    s_lshl_b32 s65, s65, 12
    s_add_u32 s65, s65, s63
    s_add_u32 m0, s58, 8192
    s_add_u32 s62, s65, 0
    buffer_load_dwordx4 v2, s[40:43], s62 offen offset:0 nt lds
    buffer_load_dwordx4 v3, s[40:43], s62 offen offset:1024 nt lds
    buffer_load_dwordx4 v4, s[40:43], s62 offen offset:2048 nt lds
    buffer_load_dwordx4 v5, s[40:43], s62 offen offset:3072 nt lds
    v_mfma_f32_16x16x16_bf16 v[48:51], v[156:157], v[180:181], v[48:51]
    v_mfma_f32_16x16x16_bf16 v[52:55], v[158:159], v[180:181], v[52:55]
    v_mfma_f32_16x16x16_bf16 v[56:59], v[160:161], v[180:181], v[56:59]
    v_mfma_f32_16x16x16_bf16 v[60:63], v[162:163], v[180:181], v[60:63]
    v_mfma_f32_16x16x16_bf16 v[64:67], v[164:165], v[180:181], v[64:67]
    v_mfma_f32_16x16x16_bf16 v[68:71], v[166:167], v[180:181], v[68:71]
    v_mfma_f32_16x16x16_bf16 v[72:75], v[168:169], v[180:181], v[72:75]
    v_mfma_f32_16x16x16_bf16 v[76:79], v[170:171], v[180:181], v[76:79]
    s_waitcnt vmcnt(12)
    ds_read_b64_tr_b16 v[156:157], v18 offset:12288
    ds_read_b64_tr_b16 v[158:159], v19 offset:12288
    ds_read_b64_tr_b16 v[160:161], v20 offset:12288
    ds_read_b64_tr_b16 v[162:163], v21 offset:12288
    ds_read_b64_tr_b16 v[164:165], v22 offset:12288
    ds_read_b64_tr_b16 v[166:167], v23 offset:12288
    ds_read_b64_tr_b16 v[168:169], v24 offset:12288
    ds_read_b64_tr_b16 v[170:171], v25 offset:12288
    s_waitcnt lgkmcnt(0)
    s_add_u32 m0, s58, 12288
    s_add_u32 s62, s65, 0
    buffer_load_dwordx4 v6, s[44:47], s62 offen offset:0 nt lds
    buffer_load_dwordx4 v7, s[44:47], s62 offen offset:1024 nt lds
    buffer_load_dwordx4 v6, s[44:47], s62 offen offset:2048 nt lds
    buffer_load_dwordx4 v7, s[44:47], s62 offen offset:3072 nt lds
    v_mfma_f32_16x16x16_bf16 v[48:51], v[156:157], v[182:183], v[48:51]
    v_mfma_f32_16x16x16_bf16 v[52:55], v[158:159], v[182:183], v[52:55]
    v_mfma_f32_16x16x16_bf16 v[56:59], v[160:161], v[182:183], v[56:59]
    v_mfma_f32_16x16x16_bf16 v[60:63], v[162:163], v[182:183], v[60:63]
    v_mfma_f32_16x16x16_bf16 v[64:67], v[164:165], v[182:183], v[64:67]
    v_mfma_f32_16x16x16_bf16 v[68:71], v[166:167], v[182:183], v[68:71]
    v_mfma_f32_16x16x16_bf16 v[72:75], v[168:169], v[182:183], v[72:75]
    v_mfma_f32_16x16x16_bf16 v[76:79], v[170:171], v[182:183], v[76:79]
    s_nop 7
    s_mov_b64 exec, s[16:17]
    ds_write_b128 v218, v[48:51] offset:0
    ds_write_b128 v218, v[52:55] offset:64
    ds_write_b128 v218, v[56:59] offset:128
    ds_write_b128 v218, v[60:63] offset:192
    ds_write_b128 v218, v[64:67] offset:256
    ds_write_b128 v218, v[68:71] offset:320
    ds_write_b128 v218, v[72:75] offset:384
    ds_write_b128 v218, v[76:79] offset:448
    s_mov_b64 exec, 1
    s_waitcnt lgkmcnt(0)
    ds_add_rtn_u32 v28, v222, v223 offset:28672
    s_mov_b64 exec, -1
    s_waitcnt lgkmcnt(0)
    v_readfirstlane_b32 s77, v28
    s_cmp_lg_u32 s77, 3
    s_cbranch_scc1 L_noqpub
    v_mul_u32_u24 v218, 528, v27
    v_lshl_add_u32 v218, v26, 5, v218
    v_lshlrev_b32 v219, 4, v1
    v_add_u32 v219, s69, v219
    ds_read_b128 v[48:51], v218 offset:0
    ds_read_b128 v[52:55], v218 offset:16
    ds_read_b128 v[56:59], v218 offset:2112
    ds_read_b128 v[60:63], v218 offset:2128
    ds_read_b128 v[64:67], v218 offset:4224
    ds_read_b128 v[68:71], v218 offset:4240
    ds_read_b128 v[72:75], v218 offset:6336
    ds_read_b128 v[76:79], v218 offset:6352
    s_waitcnt lgkmcnt(0)
    v_add_f32 v48, v48, v56
    v_add_f32 v64, v64, v72
    v_add_f32 v49, v49, v57
    v_add_f32 v65, v65, v73
    v_add_f32 v50, v50, v58
    v_add_f32 v66, v66, v74
    v_add_f32 v51, v51, v59
    v_add_f32 v67, v67, v75
    v_add_f32 v52, v52, v60
    v_add_f32 v68, v68, v76
    v_add_f32 v53, v53, v61
    v_add_f32 v69, v69, v77
    v_add_f32 v54, v54, v62
    v_add_f32 v70, v70, v78
    v_add_f32 v55, v55, v63
    v_add_f32 v71, v71, v79
    v_add_f32 v48, v48, v64
    v_add_f32 v49, v49, v65
    v_add_f32 v50, v50, v66
    v_add_f32 v51, v51, v67
    v_add_f32 v52, v52, v68
    v_add_f32 v53, v53, v69
    v_add_f32 v54, v54, v70
    v_add_f32 v55, v55, v71
    v_cvt_pk_bf16_f32 v56, v48, v49
    v_cvt_pk_bf16_f32 v57, v50, v51
    v_cvt_pk_bf16_f32 v58, v52, v53
    v_cvt_pk_bf16_f32 v59, v54, v55
    v_min_u32 v56, -2, v56
    v_min_u32 v57, -2, v57
    v_min_u32 v58, -2, v58
    v_min_u32 v59, -2, v59
    global_store_dwordx4 v219, v[56:59], s[30:31] sc1
L_noqpub:
    s_waitcnt vmcnt(12)
    ds_read_b128 a[0:3], v14 offset:0
    ds_read_b128 a[4:7], v15 offset:0
    ds_read_b128 a[8:11], v16 offset:0
    ds_read_b128 a[12:15], v17 offset:0
    s_waitcnt lgkmcnt(0)
    v_lshrrev_b32 v28, 5, v1
    v_bfe_u32 v29, v1, 1, 4
    v_and_b32 v30, 1, v1
    v_lshlrev_b32 v30, 4, v30
    v_lshl_add_u32 v30, v28, 11, v30
    v_add_u32 v31, 0, v28
    v_xor_b32 v31, v31, v29
    v_lshl_add_u32 v10, v31, 5, v30
    v_add_u32 v31, 2, v28
    v_xor_b32 v31, v31, v29
    v_lshl_add_u32 v11, v31, 5, v30
    v_add_u32 v31, 4, v28
    v_xor_b32 v31, v31, v29
    v_lshl_add_u32 v12, v31, 5, v30
    v_add_u32 v31, 6, v28
    v_xor_b32 v31, v31, v29
    v_lshl_add_u32 v13, v31, 5, v30
    s_and_b32 s60, s74, 3
    s_lshl_b32 s60, s60, 3
    s_add_u32 s60, s60, s75
    s_lshl_b32 s60, s60, 18
    s_lshl_b32 s77, s32, 14
    s_add_u32 s60, s60, s77
    s_lshl_b32 s21, s32, 12
    s_add_u32 s21, s21, 98304
    s_lshl_b32 s77, s76, 9
    s_add_u32 s60, s60, s77
    s_lshl_b32 s77, s35, 8
    s_add_u32 s70, s30, s77
    s_addc_u32 s71, s31, 0
    s_lshl_b32 s77, s32, 3
    v_lshlrev_b32 v229, 5, v1
    v_add_u32 v229, s77, v229
    v_and_b32 v231, 0xe0, v0
    s_lshl_b32 s77, s35, 8
    s_lshl_b32 s78, s36, 2
    s_add_u32 s77, s77, s78
    s_add_u32 s77, s77, 2097152
    v_add_u32 v233, s77, v231
    v_lshlrev_b32 v254, 2, v0
    s_add_u32 s65, s56, 64
    s_and_b32 s65, s65, 511
    s_lshl_b32 s65, s65, 12
    s_add_u32 s65, s65, s63
    s_add_u32 m0, s58, 0
    s_add_u32 s62, s65, 0
    buffer_load_dwordx4 v2, s[40:43], s62 offen offset:0 nt lds
    buffer_load_dwordx4 v3, s[40:43], s62 offen offset:1024 nt lds
    buffer_load_dwordx4 v4, s[40:43], s62 offen offset:2048 nt lds
    buffer_load_dwordx4 v5, s[40:43], s62 offen offset:3072 nt lds
    s_and_b32 s77, s2, 3
    s_lshl_b32 s77, s77, 11
    v_lshlrev_b32 v218, 5, v1
    v_add_u32 v219, s77, v218
    s_cmp_eq_u32 s32, 0
    s_cselect_b64 exec, -1, 1
    global_load_dwordx4 v[200:203], v219, s[4:5]
    global_load_dwordx4 v[204:207], v219, s[4:5] offset:16
    global_load_dwordx4 v[208:211], v218, s[24:25]
    global_load_dwordx4 v[212:215], v218, s[24:25] offset:16
    s_mov_b64 exec, -1
    s_waitcnt vmcnt(16)
    ds_read_b64_tr_b16 a[128:129], v18 offset:4096
    ds_read_b64_tr_b16 a[132:133], v19 offset:4096
    ds_read_b64_tr_b16 a[136:137], v20 offset:4096
    ds_read_b64_tr_b16 a[140:141], v21 offset:4096
    ds_read_b64_tr_b16 a[144:145], v22 offset:4096
    ds_read_b64_tr_b16 a[148:149], v23 offset:4096
    ds_read_b64_tr_b16 a[152:153], v24 offset:4096
    ds_read_b64_tr_b16 a[156:157], v25 offset:4096
    s_waitcnt lgkmcnt(0)
    s_add_u32 m0, s58, 4096
    s_add_u32 s62, s65, 0
    buffer_load_dwordx4 v6, s[44:47], s62 offen offset:0 nt lds
    buffer_load_dwordx4 v7, s[44:47], s62 offen offset:1024 nt lds
    buffer_load_dwordx4 v6, s[44:47], s62 offen offset:2048 nt lds
    buffer_load_dwordx4 v7, s[44:47], s62 offen offset:3072 nt lds
    s_waitcnt vmcnt(16)
    ds_read_b128 a[16:19], v14 offset:8192
    ds_read_b128 a[20:23], v15 offset:8192
    ds_read_b128 a[24:27], v16 offset:8192
    ds_read_b128 a[28:31], v17 offset:8192
    s_waitcnt lgkmcnt(0)
    s_add_u32 s65, s56, 96
    s_and_b32 s65, s65, 511
    s_lshl_b32 s65, s65, 12
    s_add_u32 s65, s65, s63
    s_add_u32 m0, s58, 8192
    s_add_u32 s62, s65, 0
    buffer_load_dwordx4 v2, s[40:43], s62 offen offset:0 nt lds
    buffer_load_dwordx4 v3, s[40:43], s62 offen offset:1024 nt lds
    buffer_load_dwordx4 v4, s[40:43], s62 offen offset:2048 nt lds
    buffer_load_dwordx4 v5, s[40:43], s62 offen offset:3072 nt lds
    s_lshr_b32 s77, s74, 2
    s_lshl_b32 s77, s77, 4
    s_and_b32 s78, s74, 3
    s_add_u32 s77, s77, s78
    s_lshl_b32 s78, s32, 2
    s_add_u32 s77, s77, s78
    s_lshl_b32 s77, s77, 3
    s_add_u32 s77, s77, s75
    s_lshl_b32 s78, s77, 11
    s_add_u32 s78, s78, 1048576
    v_lshlrev_b32 v28, 2, v1
    v_add_u32 v238, s78, v28
    s_lshl_b32 s78, s77, 5
    s_add_u32 s78, s78, 2097152
    v_mov_b32 v234, s78
    v_lshrrev_b32 v28, 2, v1
    v_and_b32 v29, 7, v28
    v_and_b32 v30, 3, v1
    v_lshlrev_b32 v30, 3, v30
    v_lshl_add_u32 v30, v28, 9, v30
    v_add_u32 v30, 98304, v30
    s_lshl_b32 s77, s32, 2
    s_add_u32 s78, s77, 0
    v_xor_b32 v31, s78, v29
    v_lshl_add_u32 v246, v31, 5, v30
    s_add_u32 s78, s77, 1
    v_xor_b32 v31, s78, v29
    v_lshl_add_u32 v247, v31, 5, v30
    s_add_u32 s78, s77, 2
    v_xor_b32 v31, s78, v29
    v_lshl_add_u32 v248, v31, 5, v30
    s_add_u32 s78, s77, 3
    v_xor_b32 v31, s78, v29
    v_lshl_add_u32 v249, v31, 5, v30
    v_and_b32 v235, 3, v1
    v_lshlrev_b32 v235, 8, v235
    v_lshl_add_u32 v235, v27, 3, v235
    s_lshl_b32 s77, s2, 6
    s_add_u32 s77, s77, 3145728
    v_lshrrev_b32 v28, 2, v1
    v_lshlrev_b32 v28, 14, v28
    v_and_b32 v29, 3, v1
    v_lshl_add_u32 v28, v29, 4, v28
    v_add_u32 v250, s77, v28
    v_add_u32 v251, 262144, v250
    v_add_u32 v252, 524288, v250
    v_add_u32 v253, 786432, v250
    s_and_b32 s77, s2, 3
    s_lshl_b32 s77, s77, 11
    s_lshr_b32 s78, s2, 2
    s_lshl_b32 s78, s78, 5
    s_add_u32 s77, s77, s78
    v_lshlrev_b32 v29, 3, v29
    v_add_u32 v237, s77, v29
    s_waitcnt vmcnt(16)
    ds_read_b64_tr_b16 a[130:131], v18 offset:12288
    ds_read_b64_tr_b16 a[134:135], v19 offset:12288
    ds_read_b64_tr_b16 a[138:139], v20 offset:12288
    ds_read_b64_tr_b16 a[142:143], v21 offset:12288
    ds_read_b64_tr_b16 a[146:147], v22 offset:12288
    ds_read_b64_tr_b16 a[150:151], v23 offset:12288
    ds_read_b64_tr_b16 a[154:155], v24 offset:12288
    ds_read_b64_tr_b16 a[158:159], v25 offset:12288
    s_waitcnt lgkmcnt(0)
    s_add_u32 m0, s58, 12288
    s_add_u32 s62, s65, 0
    buffer_load_dwordx4 v6, s[44:47], s62 offen offset:0 nt lds
    buffer_load_dwordx4 v7, s[44:47], s62 offen offset:1024 nt lds
    buffer_load_dwordx4 v6, s[44:47], s62 offen offset:2048 nt lds
    buffer_load_dwordx4 v7, s[44:47], s62 offen offset:3072 nt lds
    v_lshlrev_b32 v220, 2, v1
    global_load_dword v221, v220, s[28:29] sc1
    s_waitcnt vmcnt(17)
    ds_read_b128 a[32:35], v14 offset:0
    ds_read_b128 a[36:39], v15 offset:0
    ds_read_b128 a[40:43], v16 offset:0
    ds_read_b128 a[44:47], v17 offset:0
    s_waitcnt lgkmcnt(0)
    s_add_u32 s65, s56, 128
    s_and_b32 s65, s65, 511
    s_lshl_b32 s65, s65, 12
    s_add_u32 s65, s65, s63
    s_add_u32 m0, s58, 0
    s_add_u32 s62, s65, 0
    buffer_load_dwordx4 v2, s[40:43], s62 offen offset:0 nt lds
    buffer_load_dwordx4 v3, s[40:43], s62 offen offset:1024 nt lds
    buffer_load_dwordx4 v4, s[40:43], s62 offen offset:2048 nt lds
    buffer_load_dwordx4 v5, s[40:43], s62 offen offset:3072 nt lds
    s_waitcnt vmcnt(13)
    ds_read_b64_tr_b16 a[160:161], v18 offset:4096
    ds_read_b64_tr_b16 a[164:165], v19 offset:4096
    ds_read_b64_tr_b16 a[168:169], v20 offset:4096
    ds_read_b64_tr_b16 a[172:173], v21 offset:4096
    ds_read_b64_tr_b16 a[176:177], v22 offset:4096
    ds_read_b64_tr_b16 a[180:181], v23 offset:4096
    ds_read_b64_tr_b16 a[184:185], v24 offset:4096
    ds_read_b64_tr_b16 a[188:189], v25 offset:4096
    s_waitcnt lgkmcnt(0)
    s_add_u32 m0, s58, 4096
    s_add_u32 s62, s65, 0
    buffer_load_dwordx4 v6, s[44:47], s62 offen offset:0 nt lds
    buffer_load_dwordx4 v7, s[44:47], s62 offen offset:1024 nt lds
    buffer_load_dwordx4 v6, s[44:47], s62 offen offset:2048 nt lds
    buffer_load_dwordx4 v7, s[44:47], s62 offen offset:3072 nt lds
    s_waitcnt vmcnt(13)
    ds_read_b128 a[48:51], v14 offset:8192
    ds_read_b128 a[52:55], v15 offset:8192
    ds_read_b128 a[56:59], v16 offset:8192
    ds_read_b128 a[60:63], v17 offset:8192
    s_waitcnt lgkmcnt(0)
    s_add_u32 s65, s56, 160
    s_and_b32 s65, s65, 511
    s_lshl_b32 s65, s65, 12
    s_add_u32 s65, s65, s63
    s_add_u32 m0, s58, 8192
    s_add_u32 s62, s65, 0
    buffer_load_dwordx4 v2, s[40:43], s62 offen offset:0 nt lds
    buffer_load_dwordx4 v3, s[40:43], s62 offen offset:1024 nt lds
    buffer_load_dwordx4 v4, s[40:43], s62 offen offset:2048 nt lds
    buffer_load_dwordx4 v5, s[40:43], s62 offen offset:3072 nt lds
    s_cmp_lg_u32 s32, 0
    s_cbranch_scc1 L_nogate
    v_mov_b32 v216, 0
    v_lshlrev_b32 v28, 16, v200
    v_lshlrev_b32 v29, 16, v208
    v_fmac_f32 v216, v28, v29
    v_and_b32 v28, s72, v200
    v_and_b32 v29, s72, v208
    v_fmac_f32 v216, v28, v29
    v_lshlrev_b32 v28, 16, v201
    v_lshlrev_b32 v29, 16, v209
    v_fmac_f32 v216, v28, v29
    v_and_b32 v28, s72, v201
    v_and_b32 v29, s72, v209
    v_fmac_f32 v216, v28, v29
    v_lshlrev_b32 v28, 16, v202
    v_lshlrev_b32 v29, 16, v210
    v_fmac_f32 v216, v28, v29
    v_and_b32 v28, s72, v202
    v_and_b32 v29, s72, v210
    v_fmac_f32 v216, v28, v29
    v_lshlrev_b32 v28, 16, v203
    v_lshlrev_b32 v29, 16, v211
    v_fmac_f32 v216, v28, v29
    v_and_b32 v28, s72, v203
    v_and_b32 v29, s72, v211
    v_fmac_f32 v216, v28, v29
    v_lshlrev_b32 v28, 16, v204
    v_lshlrev_b32 v29, 16, v212
    v_fmac_f32 v216, v28, v29
    v_and_b32 v28, s72, v204
    v_and_b32 v29, s72, v212
    v_fmac_f32 v216, v28, v29
    v_lshlrev_b32 v28, 16, v205
    v_lshlrev_b32 v29, 16, v213
    v_fmac_f32 v216, v28, v29
    v_and_b32 v28, s72, v205
    v_and_b32 v29, s72, v213
    v_fmac_f32 v216, v28, v29
    v_lshlrev_b32 v28, 16, v206
    v_lshlrev_b32 v29, 16, v214
    v_fmac_f32 v216, v28, v29
    v_and_b32 v28, s72, v206
    v_and_b32 v29, s72, v214
    v_fmac_f32 v216, v28, v29
    v_lshlrev_b32 v28, 16, v207
    v_lshlrev_b32 v29, 16, v215
    v_fmac_f32 v216, v28, v29
    v_and_b32 v28, s72, v207
    v_and_b32 v29, s72, v215
    v_fmac_f32 v216, v28, v29
    s_nop 1
    v_mov_b32_dpp v28, v216 row_ror:8 row_mask:0xf bank_mask:0xf
    v_add_f32 v216, v216, v28
    s_nop 1
    v_mov_b32_dpp v28, v216 row_ror:4 row_mask:0xf bank_mask:0xf
    v_add_f32 v216, v216, v28
    s_nop 1
    v_mov_b32_dpp v28, v216 row_ror:2 row_mask:0xf bank_mask:0xf
    v_add_f32 v216, v216, v28
    s_nop 1
    v_mov_b32_dpp v28, v216 row_ror:1 row_mask:0xf bank_mask:0xf
    v_add_f32 v216, v216, v28
    v_mov_b32 v28, v216
    s_nop 1
    v_permlane32_swap_b32 v216, v28
    s_nop 0
    v_add_f32 v216, v216, v28
    v_mov_b32 v28, v216
    s_nop 1
    v_permlane16_swap_b32 v216, v28
    s_nop 0
    v_add_f32 v216, v216, v28
    v_mul_f32 v216, 0xbfb8aa3b, v216
    v_exp_f32 v216, v216
    s_nop 0
    v_add_f32 v216, 1.0, v216
    v_rcp_f32 v216, v216
L_nogate:
    s_waitcnt vmcnt(13)
    ds_read_b64_tr_b16 a[162:163], v18 offset:12288
    ds_read_b64_tr_b16 a[166:167], v19 offset:12288
    ds_read_b64_tr_b16 a[170:171], v20 offset:12288
    ds_read_b64_tr_b16 a[174:175], v21 offset:12288
    ds_read_b64_tr_b16 a[178:179], v22 offset:12288
    ds_read_b64_tr_b16 a[182:183], v23 offset:12288
    ds_read_b64_tr_b16 a[186:187], v24 offset:12288
    ds_read_b64_tr_b16 a[190:191], v25 offset:12288
    s_waitcnt lgkmcnt(0)
    s_add_u32 m0, s58, 12288
    s_add_u32 s62, s65, 0
    buffer_load_dwordx4 v6, s[44:47], s62 offen offset:0 nt lds
    buffer_load_dwordx4 v7, s[44:47], s62 offen offset:1024 nt lds
    buffer_load_dwordx4 v6, s[44:47], s62 offen offset:2048 nt lds
    buffer_load_dwordx4 v7, s[44:47], s62 offen offset:3072 nt lds
    s_waitcnt vmcnt(16)
    s_mov_b32 s67, 0
L_flagchk:
    v_cmp_gt_u32 vcc, 4, v221
    s_nop 4
    s_cbranch_vccz L_flagok
    s_add_u32 s67, s67, 1
    s_cmp_gt_u32 s67, 200000
    s_cbranch_scc1 L_flagok
    global_load_dword v221, v220, s[28:29] sc1
    s_waitcnt vmcnt(0)
    s_branch L_flagchk
L_flagok:
    s_and_b32 s77, s38, 3
    s_lshl_b32 s78, s37, 2
    s_add_u32 s77, s77, s78
    s_lshl_b32 s77, s77, 15
    s_lshr_b32 s78, s38, 2
    s_lshl_b32 s78, s78, 8
    s_add_u32 s77, s77, s78
    s_add_u32 s77, s77, 65536
    v_lshrrev_b32 v218, 5, v0
    v_lshlrev_b32 v218, 12, v218
    v_and_b32 v219, 31, v0
    v_lshl_add_u32 v218, v219, 3, v218
    v_add_u32 v218, s77, v218
    s_cmp_eq_u32 s79, 0
    s_cselect_b64 exec, -1, 1
    global_load_dwordx2 v[184:185], v218, s[30:31] offset:0 sc1
    global_load_dwordx2 v[186:187], v218, s[30:31] offset:1024 sc1
    global_load_dwordx2 v[188:189], v218, s[30:31] offset:2048 sc1
    global_load_dwordx2 v[190:191], v218, s[30:31] offset:3072 sc1
    s_mov_b64 exec, -1
    s_cmp_lg_u32 s66, 0
    s_cbranch_scc1 L_c_3
    s_mov_b32 s64, 1
    s_atomic_add s64, s[70:71], 0x0 glc
L_c_3:
    s_waitcnt vmcnt(16)
    ds_read_b128 a[64:67], v14 offset:0
    ds_read_b128 a[68:71], v15 offset:0
    ds_read_b128 a[72:75], v16 offset:0
    ds_read_b128 a[76:79], v17 offset:0
    s_waitcnt lgkmcnt(0)
    s_cmp_lg_u32 s66, 0
    s_cbranch_scc1 L_e2_6
    s_cmp_ge_u32 s64, 320
    s_cbranch_scc1 L_e1_6
    s_sub_u32 s18, s64, s19
    s_mov_b32 s19, s64
    s_add_u32 s65, s64, s3
    s_and_b32 s65, s65, 511
    s_lshl_b32 s65, s65, 12
    s_add_u32 s65, s65, s63
    s_add_u32 m0, s58, 0
    s_add_u32 s62, s65, 0
    buffer_load_dwordx4 v2, s[40:43], s62 offen offset:0 nt lds
    buffer_load_dwordx4 v3, s[40:43], s62 offen offset:1024 nt lds
    buffer_load_dwordx4 v4, s[40:43], s62 offen offset:2048 nt lds
    buffer_load_dwordx4 v5, s[40:43], s62 offen offset:3072 nt lds
    s_branch L_ea_6
L_e2_6:
    s_mov_b32 s66, 1
L_e1_6:
    s_add_u32 s66, s66, 1
    s_or_b32 s20, s20, 1
    s_add_u32 m0, s21, 0
    s_add_u32 s62, s60, 0
    buffer_load_dwordx4 v10, s[52:55], s62 offen nt lds
    s_add_u32 m0, s21, 1024
    s_add_u32 s62, s60, 4096
    buffer_load_dwordx4 v11, s[52:55], s62 offen nt lds
    s_add_u32 m0, s21, 2048
    s_add_u32 s62, s60, 8192
    buffer_load_dwordx4 v12, s[52:55], s62 offen nt lds
    s_add_u32 m0, s21, 3072
    s_add_u32 s62, s60, 12288
    buffer_load_dwordx4 v13, s[52:55], s62 offen nt lds
L_ea_6:
    s_waitcnt vmcnt(16)
    ds_read_b64_tr_b16 a[192:193], v18 offset:4096
    ds_read_b64_tr_b16 a[196:197], v19 offset:4096
    ds_read_b64_tr_b16 a[200:201], v20 offset:4096
    ds_read_b64_tr_b16 a[204:205], v21 offset:4096
    ds_read_b64_tr_b16 a[208:209], v22 offset:4096
    ds_read_b64_tr_b16 a[212:213], v23 offset:4096
    ds_read_b64_tr_b16 a[216:217], v24 offset:4096
    ds_read_b64_tr_b16 a[220:221], v25 offset:4096
    s_waitcnt lgkmcnt(0)
    s_cmp_lg_u32 s66, 0
    s_cbranch_scc1 L_ew_6
    s_add_u32 m0, s58, 4096
    s_add_u32 s62, s65, 0
    buffer_load_dwordx4 v6, s[44:47], s62 offen offset:0 nt lds
    buffer_load_dwordx4 v7, s[44:47], s62 offen offset:1024 nt lds
    buffer_load_dwordx4 v6, s[44:47], s62 offen offset:2048 nt lds
    buffer_load_dwordx4 v7, s[44:47], s62 offen offset:3072 nt lds
    s_branch L_eb_6
L_ew_6:
    s_cmp_eq_u32 s66, 2
    s_mov_b32 s73, 5
    s_mov_b32 s65, 1
    s_cbranch_scc1 L_early
    s_or_b32 s20, s20, 2
    s_add_u32 m0, s21, 16384
    s_add_u32 s62, s60, 65536
    buffer_load_dwordx4 v10, s[52:55], s62 offen nt lds
    s_add_u32 m0, s21, 17408
    s_add_u32 s62, s60, 69632
    buffer_load_dwordx4 v11, s[52:55], s62 offen nt lds
    s_add_u32 m0, s21, 18432
    s_add_u32 s62, s60, 73728
    buffer_load_dwordx4 v12, s[52:55], s62 offen nt lds
    s_add_u32 m0, s21, 19456
    s_add_u32 s62, s60, 77824
    buffer_load_dwordx4 v13, s[52:55], s62 offen nt lds
L_eb_6:
    s_cmp_lg_u32 s66, 0
    s_cbranch_scc1 L_c_4
    s_mov_b32 s64, 1
    s_atomic_add s64, s[70:71], 0x0 glc
L_c_4:
    s_waitcnt vmcnt(16)
    ds_read_b128 a[80:83], v14 offset:8192
    ds_read_b128 a[84:87], v15 offset:8192
    ds_read_b128 a[88:91], v16 offset:8192
    ds_read_b128 a[92:95], v17 offset:8192
    s_waitcnt lgkmcnt(0)
    s_cmp_lg_u32 s66, 0
    s_cbranch_scc1 L_e2_7
    s_cmp_ge_u32 s64, 320
    s_cbranch_scc1 L_e1_7
    s_sub_u32 s18, s64, s19
    s_mov_b32 s19, s64
    s_add_u32 s65, s64, s3
    s_and_b32 s65, s65, 511
    s_lshl_b32 s65, s65, 12
    s_add_u32 s65, s65, s63
    s_add_u32 m0, s58, 8192
    s_add_u32 s62, s65, 0
    buffer_load_dwordx4 v2, s[40:43], s62 offen offset:0 nt lds
    buffer_load_dwordx4 v3, s[40:43], s62 offen offset:1024 nt lds
    buffer_load_dwordx4 v4, s[40:43], s62 offen offset:2048 nt lds
    buffer_load_dwordx4 v5, s[40:43], s62 offen offset:3072 nt lds
    s_branch L_ea_7
L_e2_7:
    s_mov_b32 s66, 1
L_e1_7:
    s_add_u32 s66, s66, 1
    s_or_b32 s20, s20, 4
    s_add_u32 m0, s21, 32768
    s_add_u32 s62, s60, 131072
    buffer_load_dwordx4 v10, s[52:55], s62 offen nt lds
    s_add_u32 m0, s21, 33792
    s_add_u32 s62, s60, 135168
    buffer_load_dwordx4 v11, s[52:55], s62 offen nt lds
    s_add_u32 m0, s21, 34816
    s_add_u32 s62, s60, 139264
    buffer_load_dwordx4 v12, s[52:55], s62 offen nt lds
    s_add_u32 m0, s21, 35840
    s_add_u32 s62, s60, 143360
    buffer_load_dwordx4 v13, s[52:55], s62 offen nt lds
L_ea_7:
    s_waitcnt vmcnt(16)
    ds_read_b64_tr_b16 a[194:195], v18 offset:12288
    ds_read_b64_tr_b16 a[198:199], v19 offset:12288
    ds_read_b64_tr_b16 a[202:203], v20 offset:12288
    ds_read_b64_tr_b16 a[206:207], v21 offset:12288
    ds_read_b64_tr_b16 a[210:211], v22 offset:12288
    ds_read_b64_tr_b16 a[214:215], v23 offset:12288
    ds_read_b64_tr_b16 a[218:219], v24 offset:12288
    ds_read_b64_tr_b16 a[222:223], v25 offset:12288
    s_waitcnt lgkmcnt(0)
    s_cmp_lg_u32 s66, 0
    s_cbranch_scc1 L_ew_7
    s_add_u32 m0, s58, 12288
    s_add_u32 s62, s65, 0
    buffer_load_dwordx4 v6, s[44:47], s62 offen offset:0 nt lds
    buffer_load_dwordx4 v7, s[44:47], s62 offen offset:1024 nt lds
    buffer_load_dwordx4 v6, s[44:47], s62 offen offset:2048 nt lds
    buffer_load_dwordx4 v7, s[44:47], s62 offen offset:3072 nt lds
    s_branch L_eb_7
L_ew_7:
    s_cmp_eq_u32 s66, 2
    s_mov_b32 s73, 6
    s_mov_b32 s65, 3
    s_cbranch_scc1 L_early
    s_or_b32 s20, s20, 8
    s_add_u32 m0, s21, 49152
    s_add_u32 s62, s60, 196608
    buffer_load_dwordx4 v10, s[52:55], s62 offen nt lds
    s_add_u32 m0, s21, 50176
    s_add_u32 s62, s60, 200704
    buffer_load_dwordx4 v11, s[52:55], s62 offen nt lds
    s_add_u32 m0, s21, 51200
    s_add_u32 s62, s60, 204800
    buffer_load_dwordx4 v12, s[52:55], s62 offen nt lds
    s_add_u32 m0, s21, 52224
    s_add_u32 s62, s60, 208896
    buffer_load_dwordx4 v13, s[52:55], s62 offen nt lds
L_eb_7:
    s_waitcnt vmcnt(16)
    s_cmp_lg_u32 s79, 0
    s_cbranch_scc1 L_qt_s5
    v_max3_u32 v28, v184, v185, v186
    v_max3_u32 v28, v28, v187, v188
    v_max3_u32 v28, v28, v189, v190
    v_max_u32 v28, v28, v191
    v_cmp_eq_u32 vcc, -1, v28
    s_nop 4
    s_cbranch_vccnz L_qt_s5
    v_lshlrev_b32 v192, 16, v184
    v_and_b32 v193, s72, v184
    v_lshlrev_b32 v194, 16, v185
    v_and_b32 v195, s72, v185
    v_lshlrev_b32 v28, 16, v186
    v_and_b32 v29, s72, v186
    v_add_f32 v192, v192, v28
    v_add_f32 v193, v193, v29
    v_lshlrev_b32 v28, 16, v187
    v_and_b32 v29, s72, v187
    v_add_f32 v194, v194, v28
    v_add_f32 v195, v195, v29
    v_lshlrev_b32 v28, 16, v188
    v_and_b32 v29, s72, v188
    v_add_f32 v192, v192, v28
    v_add_f32 v193, v193, v29
    v_lshlrev_b32 v28, 16, v189
    v_and_b32 v29, s72, v189
    v_add_f32 v194, v194, v28
    v_add_f32 v195, v195, v29
    v_lshlrev_b32 v28, 16, v190
    v_and_b32 v29, s72, v190
    v_add_f32 v192, v192, v28
    v_add_f32 v193, v193, v29
    v_lshlrev_b32 v28, 16, v191
    v_and_b32 v29, s72, v191
    v_add_f32 v194, v194, v28
    v_add_f32 v195, v195, v29
    v_cvt_pk_bf16_f32 v196, v192, v193
    v_cvt_pk_bf16_f32 v197, v194, v195
    v_lshlrev_b32 v219, 3, v0
    ds_write_b64 v219, v[196:197] offset:8448
    s_mov_b64 exec, 1
    s_waitcnt lgkmcnt(0)
    ds_add_u32 v222, v223 offset:28676
    s_mov_b64 exec, -1
    s_mov_b32 s79, 1
    s_waitcnt lgkmcnt(0)
L_qt_s5:
    s_cmp_eq_u32 s79, 0
    s_cselect_b64 exec, -1, 1
    global_load_dwordx2 v[184:185], v218, s[30:31] offset:0 sc1
    global_load_dwordx2 v[186:187], v218, s[30:31] offset:1024 sc1
    global_load_dwordx2 v[188:189], v218, s[30:31] offset:2048 sc1
    global_load_dwordx2 v[190:191], v218, s[30:31] offset:3072 sc1
    s_mov_b64 exec, -1
    s_cmp_lg_u32 s66, 0
    s_cbranch_scc1 L_c_5
    s_mov_b32 s64, 1
    s_atomic_add s64, s[70:71], 0x0 glc
L_c_5:
    s_waitcnt vmcnt(16)
    ds_read_b128 a[96:99], v14 offset:0
    ds_read_b128 a[100:103], v15 offset:0
    ds_read_b128 a[104:107], v16 offset:0
    ds_read_b128 a[108:111], v17 offset:0
    s_waitcnt lgkmcnt(0)
    s_cmp_lg_u32 s66, 0
    s_cbranch_scc1 L_e2_8
    s_cmp_ge_u32 s64, 320
    s_cbranch_scc1 L_e1_8
    s_sub_u32 s18, s64, s19
    s_mov_b32 s19, s64
    s_add_u32 s65, s64, s3
    s_and_b32 s65, s65, 511
    s_lshl_b32 s65, s65, 12
    s_add_u32 s65, s65, s63
    s_add_u32 m0, s58, 0
    s_add_u32 s62, s65, 0
    buffer_load_dwordx4 v2, s[40:43], s62 offen offset:0 nt lds
    buffer_load_dwordx4 v3, s[40:43], s62 offen offset:1024 nt lds
    buffer_load_dwordx4 v4, s[40:43], s62 offen offset:2048 nt lds
    buffer_load_dwordx4 v5, s[40:43], s62 offen offset:3072 nt lds
    s_branch L_ea_8
L_e2_8:
    s_mov_b32 s66, 1
L_e1_8:
    s_add_u32 s66, s66, 1
    s_or_b32 s20, s20, 1
    s_add_u32 m0, s21, 0
    s_add_u32 s62, s60, 0
    buffer_load_dwordx4 v10, s[52:55], s62 offen nt lds
    s_add_u32 m0, s21, 1024
    s_add_u32 s62, s60, 4096
    buffer_load_dwordx4 v11, s[52:55], s62 offen nt lds
    s_add_u32 m0, s21, 2048
    s_add_u32 s62, s60, 8192
    buffer_load_dwordx4 v12, s[52:55], s62 offen nt lds
    s_add_u32 m0, s21, 3072
    s_add_u32 s62, s60, 12288
    buffer_load_dwordx4 v13, s[52:55], s62 offen nt lds
L_ea_8:
    s_waitcnt vmcnt(16)
    ds_read_b64_tr_b16 a[224:225], v18 offset:4096
    ds_read_b64_tr_b16 a[228:229], v19 offset:4096
    ds_read_b64_tr_b16 a[232:233], v20 offset:4096
    ds_read_b64_tr_b16 a[236:237], v21 offset:4096
    ds_read_b64_tr_b16 a[240:241], v22 offset:4096
    ds_read_b64_tr_b16 a[244:245], v23 offset:4096
    ds_read_b64_tr_b16 a[248:249], v24 offset:4096
    ds_read_b64_tr_b16 a[252:253], v25 offset:4096
    s_waitcnt lgkmcnt(0)
    s_cmp_lg_u32 s66, 0
    s_cbranch_scc1 L_ew_8
    s_add_u32 m0, s58, 4096
    s_add_u32 s62, s65, 0
    buffer_load_dwordx4 v6, s[44:47], s62 offen offset:0 nt lds
    buffer_load_dwordx4 v7, s[44:47], s62 offen offset:1024 nt lds
    buffer_load_dwordx4 v6, s[44:47], s62 offen offset:2048 nt lds
    buffer_load_dwordx4 v7, s[44:47], s62 offen offset:3072 nt lds
    s_branch L_eb_8
L_ew_8:
    s_cmp_eq_u32 s66, 2
    s_mov_b32 s73, 7
    s_mov_b32 s65, 1
    s_cbranch_scc1 L_early
    s_or_b32 s20, s20, 2
    s_add_u32 m0, s21, 16384
    s_add_u32 s62, s60, 65536
    buffer_load_dwordx4 v10, s[52:55], s62 offen nt lds
    s_add_u32 m0, s21, 17408
    s_add_u32 s62, s60, 69632
    buffer_load_dwordx4 v11, s[52:55], s62 offen nt lds
    s_add_u32 m0, s21, 18432
    s_add_u32 s62, s60, 73728
    buffer_load_dwordx4 v12, s[52:55], s62 offen nt lds
    s_add_u32 m0, s21, 19456
    s_add_u32 s62, s60, 77824
    buffer_load_dwordx4 v13, s[52:55], s62 offen nt lds
L_eb_8:
    s_cmp_lg_u32 s66, 0
    s_cbranch_scc1 L_c_6
    s_mov_b32 s64, 1
    s_atomic_add s64, s[70:71], 0x0 glc
L_c_6:
    s_waitcnt vmcnt(16)
    ds_read_b128 a[112:115], v14 offset:8192
    ds_read_b128 a[116:119], v15 offset:8192
    ds_read_b128 a[120:123], v16 offset:8192
    ds_read_b128 a[124:127], v17 offset:8192
    s_waitcnt lgkmcnt(0)
    s_cmp_lg_u32 s66, 0
    s_cbranch_scc1 L_e2_9
    s_cmp_ge_u32 s64, 320
    s_cbranch_scc1 L_e1_9
    s_sub_u32 s18, s64, s19
    s_mov_b32 s19, s64
    s_add_u32 s65, s64, s3
    s_and_b32 s65, s65, 511
    s_lshl_b32 s65, s65, 12
    s_add_u32 s65, s65, s63
    s_add_u32 m0, s58, 8192
    s_add_u32 s62, s65, 0
    buffer_load_dwordx4 v2, s[40:43], s62 offen offset:0 nt lds
    buffer_load_dwordx4 v3, s[40:43], s62 offen offset:1024 nt lds
    buffer_load_dwordx4 v4, s[40:43], s62 offen offset:2048 nt lds
    buffer_load_dwordx4 v5, s[40:43], s62 offen offset:3072 nt lds
    s_branch L_ea_9
L_e2_9:
    s_mov_b32 s66, 1
L_e1_9:
    s_add_u32 s66, s66, 1
    s_or_b32 s20, s20, 4
    s_add_u32 m0, s21, 32768
    s_add_u32 s62, s60, 131072
    buffer_load_dwordx4 v10, s[52:55], s62 offen nt lds
    s_add_u32 m0, s21, 33792
    s_add_u32 s62, s60, 135168
    buffer_load_dwordx4 v11, s[52:55], s62 offen nt lds
    s_add_u32 m0, s21, 34816
    s_add_u32 s62, s60, 139264
    buffer_load_dwordx4 v12, s[52:55], s62 offen nt lds
    s_add_u32 m0, s21, 35840
    s_add_u32 s62, s60, 143360
    buffer_load_dwordx4 v13, s[52:55], s62 offen nt lds
L_ea_9:
    s_waitcnt vmcnt(16)
    ds_read_b64_tr_b16 a[226:227], v18 offset:12288
    ds_read_b64_tr_b16 a[230:231], v19 offset:12288
    ds_read_b64_tr_b16 a[234:235], v20 offset:12288
    ds_read_b64_tr_b16 a[238:239], v21 offset:12288
    ds_read_b64_tr_b16 a[242:243], v22 offset:12288
    ds_read_b64_tr_b16 a[246:247], v23 offset:12288
    ds_read_b64_tr_b16 a[250:251], v24 offset:12288
    ds_read_b64_tr_b16 a[254:255], v25 offset:12288
    s_waitcnt lgkmcnt(0)
    s_cmp_lg_u32 s66, 0
    s_cbranch_scc1 L_ew_9
    s_add_u32 m0, s58, 12288
    s_add_u32 s62, s65, 0
    buffer_load_dwordx4 v6, s[44:47], s62 offen offset:0 nt lds
    buffer_load_dwordx4 v7, s[44:47], s62 offen offset:1024 nt lds
    buffer_load_dwordx4 v6, s[44:47], s62 offen offset:2048 nt lds
    buffer_load_dwordx4 v7, s[44:47], s62 offen offset:3072 nt lds
    s_branch L_eb_9
L_ew_9:
    s_cmp_eq_u32 s66, 2
    s_mov_b32 s73, 8
    s_mov_b32 s65, 3
    s_cbranch_scc1 L_batch
    s_or_b32 s20, s20, 8
    s_add_u32 m0, s21, 49152
    s_add_u32 s62, s60, 196608
    buffer_load_dwordx4 v10, s[52:55], s62 offen nt lds
    s_add_u32 m0, s21, 50176
    s_add_u32 s62, s60, 200704
    buffer_load_dwordx4 v11, s[52:55], s62 offen nt lds
    s_add_u32 m0, s21, 51200
    s_add_u32 s62, s60, 204800
    buffer_load_dwordx4 v12, s[52:55], s62 offen nt lds
    s_add_u32 m0, s21, 52224
    s_add_u32 s62, s60, 208896
    buffer_load_dwordx4 v13, s[52:55], s62 offen nt lds
L_eb_9:
    s_waitcnt vmcnt(16)
    s_cmp_lg_u32 s79, 0
    s_cbranch_scc1 L_qt_s7
    v_max3_u32 v28, v184, v185, v186
    v_max3_u32 v28, v28, v187, v188
    v_max3_u32 v28, v28, v189, v190
    v_max_u32 v28, v28, v191
    v_cmp_eq_u32 vcc, -1, v28
    s_nop 4
    s_cbranch_vccnz L_qt_s7
    v_lshlrev_b32 v192, 16, v184
    v_and_b32 v193, s72, v184
    v_lshlrev_b32 v194, 16, v185
    v_and_b32 v195, s72, v185
    v_lshlrev_b32 v28, 16, v186
    v_and_b32 v29, s72, v186
    v_add_f32 v192, v192, v28
    v_add_f32 v193, v193, v29
    v_lshlrev_b32 v28, 16, v187
    v_and_b32 v29, s72, v187
    v_add_f32 v194, v194, v28
    v_add_f32 v195, v195, v29
    v_lshlrev_b32 v28, 16, v188
    v_and_b32 v29, s72, v188
    v_add_f32 v192, v192, v28
    v_add_f32 v193, v193, v29
    v_lshlrev_b32 v28, 16, v189
    v_and_b32 v29, s72, v189
    v_add_f32 v194, v194, v28
    v_add_f32 v195, v195, v29
    v_lshlrev_b32 v28, 16, v190
    v_and_b32 v29, s72, v190
    v_add_f32 v192, v192, v28
    v_add_f32 v193, v193, v29
    v_lshlrev_b32 v28, 16, v191
    v_and_b32 v29, s72, v191
    v_add_f32 v194, v194, v28
    v_add_f32 v195, v195, v29
    v_cvt_pk_bf16_f32 v196, v192, v193
    v_cvt_pk_bf16_f32 v197, v194, v195
    v_lshlrev_b32 v219, 3, v0
    ds_write_b64 v219, v[196:197] offset:8448
    s_mov_b64 exec, 1
    s_waitcnt lgkmcnt(0)
    ds_add_u32 v222, v223 offset:28676
    s_mov_b64 exec, -1
    s_mov_b32 s79, 1
    s_waitcnt lgkmcnt(0)
L_qt_s7:
    s_mov_b32 s73, 8
    s_branch L_batch
L_early:
    s_waitcnt vmcnt(0)
    s_cmp_gt_u32 s73, 6
    s_cbranch_scc1 L_ez_6
    v_accvgpr_write_b32 a224, 0
    v_accvgpr_write_b32 a225, 0
    v_accvgpr_write_b32 a228, 0
    v_accvgpr_write_b32 a229, 0
    v_accvgpr_write_b32 a232, 0
    v_accvgpr_write_b32 a233, 0
    v_accvgpr_write_b32 a236, 0
    v_accvgpr_write_b32 a237, 0
    v_accvgpr_write_b32 a240, 0
    v_accvgpr_write_b32 a241, 0
    v_accvgpr_write_b32 a244, 0
    v_accvgpr_write_b32 a245, 0
    v_accvgpr_write_b32 a248, 0
    v_accvgpr_write_b32 a249, 0
    v_accvgpr_write_b32 a252, 0
    v_accvgpr_write_b32 a253, 0
L_ez_6:
    s_cmp_gt_u32 s73, 7
    s_cbranch_scc1 L_ez_7
    v_accvgpr_write_b32 a226, 0
    v_accvgpr_write_b32 a227, 0
    v_accvgpr_write_b32 a230, 0
    v_accvgpr_write_b32 a231, 0
    v_accvgpr_write_b32 a234, 0
    v_accvgpr_write_b32 a235, 0
    v_accvgpr_write_b32 a238, 0
    v_accvgpr_write_b32 a239, 0
    v_accvgpr_write_b32 a242, 0
    v_accvgpr_write_b32 a243, 0
    v_accvgpr_write_b32 a246, 0
    v_accvgpr_write_b32 a247, 0
    v_accvgpr_write_b32 a250, 0
    v_accvgpr_write_b32 a251, 0
    v_accvgpr_write_b32 a254, 0
    v_accvgpr_write_b32 a255, 0
L_ez_7:
L_batch:
    s_cmp_lg_u32 s79, 0
    s_cbranch_scc1 L_qok
    s_mov_b32 s67, 0
L_qchk:
    global_load_dwordx2 v[184:185], v218, s[30:31] offset:0 sc1
    global_load_dwordx2 v[186:187], v218, s[30:31] offset:1024 sc1
    global_load_dwordx2 v[188:189], v218, s[30:31] offset:2048 sc1
    global_load_dwordx2 v[190:191], v218, s[30:31] offset:3072 sc1
    s_waitcnt vmcnt(0)
    v_max3_u32 v28, v184, v185, v186
    v_max3_u32 v28, v28, v187, v188
    v_max3_u32 v28, v28, v189, v190
    v_max_u32 v28, v28, v191
    v_cmp_eq_u32 vcc, -1, v28
    s_add_u32 s67, s67, 1
    s_cmp_gt_u32 s67, 200000
    s_cbranch_scc1 L_qd
    s_nop 2
    s_cbranch_vccnz L_qchk
L_qd:
    v_lshlrev_b32 v192, 16, v184
    v_and_b32 v193, s72, v184
    v_lshlrev_b32 v194, 16, v185
    v_and_b32 v195, s72, v185
    v_lshlrev_b32 v28, 16, v186
    v_and_b32 v29, s72, v186
    v_add_f32 v192, v192, v28
    v_add_f32 v193, v193, v29
    v_lshlrev_b32 v28, 16, v187
    v_and_b32 v29, s72, v187
    v_add_f32 v194, v194, v28
    v_add_f32 v195, v195, v29
    v_lshlrev_b32 v28, 16, v188
    v_and_b32 v29, s72, v188
    v_add_f32 v192, v192, v28
    v_add_f32 v193, v193, v29
    v_lshlrev_b32 v28, 16, v189
    v_and_b32 v29, s72, v189
    v_add_f32 v194, v194, v28
    v_add_f32 v195, v195, v29
    v_lshlrev_b32 v28, 16, v190
    v_and_b32 v29, s72, v190
    v_add_f32 v192, v192, v28
    v_add_f32 v193, v193, v29
    v_lshlrev_b32 v28, 16, v191
    v_and_b32 v29, s72, v191
    v_add_f32 v194, v194, v28
    v_add_f32 v195, v195, v29
    v_cvt_pk_bf16_f32 v196, v192, v193
    v_cvt_pk_bf16_f32 v197, v194, v195
    v_lshlrev_b32 v219, 3, v0
    ds_write_b64 v219, v[196:197] offset:8448
    s_mov_b64 exec, 1
    s_waitcnt lgkmcnt(0)
    ds_add_u32 v222, v223 offset:28676
    s_mov_b64 exec, -1
    s_mov_b32 s79, 1
    s_waitcnt lgkmcnt(0)
L_qok:
    v_and_b32 v218, 7, v1
    v_lshlrev_b32 v218, 8, v218
    v_lshl_add_u32 v218, v27, 4, v218
    s_mov_b32 s67, 0
L_qw:
    ds_read_b32 v28, v222 offset:28676
    s_waitcnt lgkmcnt(0)
    v_readfirstlane_b32 s77, v28
    s_add_u32 s67, s67, 1
    s_cmp_gt_u32 s67, 10000000
    s_cbranch_scc1 L_qwok
    s_cmp_lt_u32 s77, 4
    s_cbranch_scc1 L_qw
L_qwok:
    ds_read_b128 v[32:35], v218 offset:8448
    ds_read_b128 v[36:39], v218 offset:8512
    ds_read_b128 v[40:43], v218 offset:8576
    ds_read_b128 v[44:47], v218 offset:8640
    s_waitcnt lgkmcnt(0)
    s_cmp_lg_u32 s66, 0
    s_cbranch_scc1 L_c_b
    s_mov_b32 s64, 1
    s_atomic_add s64, s[70:71], 0x0 glc
L_c_b:
    v_mfma_f32_16x16x32_bf16 v[80:83], a[0:3], v[32:35], 0
    v_mfma_f32_16x16x32_bf16 v[84:87], a[16:19], v[32:35], 0
    v_mfma_f32_16x16x32_bf16 v[88:91], a[32:35], v[32:35], 0
    v_mfma_f32_16x16x32_bf16 v[92:95], a[48:51], v[32:35], 0
    v_mfma_f32_16x16x32_bf16 v[96:99], a[64:67], v[32:35], 0
    v_mfma_f32_16x16x32_bf16 v[100:103], a[80:83], v[32:35], 0
    v_mfma_f32_16x16x32_bf16 v[104:107], a[96:99], v[32:35], 0
    v_mfma_f32_16x16x32_bf16 v[108:111], a[112:115], v[32:35], 0
    v_mfma_f32_16x16x32_bf16 v[80:83], a[4:7], v[36:39], v[80:83]
    v_mfma_f32_16x16x32_bf16 v[84:87], a[20:23], v[36:39], v[84:87]
    v_mfma_f32_16x16x32_bf16 v[88:91], a[36:39], v[36:39], v[88:91]
    v_mfma_f32_16x16x32_bf16 v[92:95], a[52:55], v[36:39], v[92:95]
    v_mfma_f32_16x16x32_bf16 v[96:99], a[68:71], v[36:39], v[96:99]
    v_mfma_f32_16x16x32_bf16 v[100:103], a[84:87], v[36:39], v[100:103]
    v_mfma_f32_16x16x32_bf16 v[104:107], a[100:103], v[36:39], v[104:107]
    v_mfma_f32_16x16x32_bf16 v[108:111], a[116:119], v[36:39], v[108:111]
    v_mfma_f32_16x16x32_bf16 v[80:83], a[8:11], v[40:43], v[80:83]
    v_mfma_f32_16x16x32_bf16 v[84:87], a[24:27], v[40:43], v[84:87]
    v_mfma_f32_16x16x32_bf16 v[88:91], a[40:43], v[40:43], v[88:91]
    v_mfma_f32_16x16x32_bf16 v[92:95], a[56:59], v[40:43], v[92:95]
    v_mfma_f32_16x16x32_bf16 v[96:99], a[72:75], v[40:43], v[96:99]
    v_mfma_f32_16x16x32_bf16 v[100:103], a[88:91], v[40:43], v[100:103]
    v_mfma_f32_16x16x32_bf16 v[104:107], a[104:107], v[40:43], v[104:107]
    v_mfma_f32_16x16x32_bf16 v[108:111], a[120:123], v[40:43], v[108:111]
    v_mfma_f32_16x16x32_bf16 v[80:83], a[12:15], v[44:47], v[80:83]
    v_mfma_f32_16x16x32_bf16 v[84:87], a[28:31], v[44:47], v[84:87]
    v_mfma_f32_16x16x32_bf16 v[88:91], a[44:47], v[44:47], v[88:91]
    v_mfma_f32_16x16x32_bf16 v[92:95], a[60:63], v[44:47], v[92:95]
    v_mfma_f32_16x16x32_bf16 v[96:99], a[76:79], v[44:47], v[96:99]
    v_mfma_f32_16x16x32_bf16 v[100:103], a[92:95], v[44:47], v[100:103]
    v_mfma_f32_16x16x32_bf16 v[104:107], a[108:111], v[44:47], v[104:107]
    v_mfma_f32_16x16x32_bf16 v[108:111], a[124:127], v[44:47], v[108:111]
    s_nop 7
    s_cmp_eq_u32 s73, 8
    s_cbranch_scc1 L_nomask
    s_cmp_gt_u32 s73, 6
    s_cbranch_scc1 L_em_6
    v_mov_b32 v104, 0xff7fffff
    v_mov_b32 v105, 0xff7fffff
    v_mov_b32 v106, 0xff7fffff
    v_mov_b32 v107, 0xff7fffff
L_em_6:
    s_cmp_gt_u32 s73, 7
    s_cbranch_scc1 L_em_7
    v_mov_b32 v108, 0xff7fffff
    v_mov_b32 v109, 0xff7fffff
    v_mov_b32 v110, 0xff7fffff
    v_mov_b32 v111, 0xff7fffff
L_em_7:
L_nomask:
    v_max3_f32 v172, v80, v81, v82
    v_max3_f32 v172, v172, v83, v84
    v_max3_f32 v172, v172, v85, v86
    v_max3_f32 v172, v172, v87, v88
    v_max3_f32 v172, v172, v89, v90
    v_max3_f32 v172, v172, v91, v92
    v_max3_f32 v172, v172, v93, v94
    v_max3_f32 v172, v172, v95, v96
    v_max3_f32 v172, v172, v97, v98
    v_max3_f32 v172, v172, v99, v100
    v_max3_f32 v172, v172, v101, v102
    v_max3_f32 v172, v172, v103, v104
    v_max3_f32 v172, v172, v105, v106
    v_max3_f32 v172, v172, v107, v108
    v_max3_f32 v172, v172, v109, v110
    v_max_f32 v172, v172, v111
    v_mov_b32 v28, v172
    s_nop 1
    v_permlane32_swap_b32 v172, v28
    s_nop 0
    v_max_f32 v172, v172, v28
    v_mov_b32 v28, v172
    s_nop 1
    v_permlane16_swap_b32 v172, v28
    s_nop 0
    v_max_f32 v172, v172, v28
    v_mul_f32 v174, s68, v172
    v_fma_f32 v80, v80, s68, -v174
    v_fma_f32 v81, v81, s68, -v174
    v_fma_f32 v82, v82, s68, -v174
    v_fma_f32 v83, v83, s68, -v174
    v_fma_f32 v84, v84, s68, -v174
    v_fma_f32 v85, v85, s68, -v174
    v_fma_f32 v86, v86, s68, -v174
    v_fma_f32 v87, v87, s68, -v174
    v_fma_f32 v88, v88, s68, -v174
    v_fma_f32 v89, v89, s68, -v174
    v_fma_f32 v90, v90, s68, -v174
    v_fma_f32 v91, v91, s68, -v174
    v_fma_f32 v92, v92, s68, -v174
    v_fma_f32 v93, v93, s68, -v174
    v_fma_f32 v94, v94, s68, -v174
    v_fma_f32 v95, v95, s68, -v174
    v_fma_f32 v96, v96, s68, -v174
    v_fma_f32 v97, v97, s68, -v174
    v_fma_f32 v98, v98, s68, -v174
    v_fma_f32 v99, v99, s68, -v174
    v_fma_f32 v100, v100, s68, -v174
    v_fma_f32 v101, v101, s68, -v174
    v_fma_f32 v102, v102, s68, -v174
    v_fma_f32 v103, v103, s68, -v174
    v_fma_f32 v104, v104, s68, -v174
    v_fma_f32 v105, v105, s68, -v174
    v_fma_f32 v106, v106, s68, -v174
    v_fma_f32 v107, v107, s68, -v174
    v_fma_f32 v108, v108, s68, -v174
    v_fma_f32 v109, v109, s68, -v174
    v_fma_f32 v110, v110, s68, -v174
    v_fma_f32 v111, v111, s68, -v174
    v_exp_f32 v80, v80
    v_exp_f32 v81, v81
    v_exp_f32 v82, v82
    v_exp_f32 v83, v83
    v_exp_f32 v84, v84
    v_exp_f32 v85, v85
    v_exp_f32 v86, v86
    v_exp_f32 v87, v87
    v_exp_f32 v88, v88
    v_exp_f32 v89, v89
    v_exp_f32 v90, v90
    v_exp_f32 v91, v91
    v_exp_f32 v92, v92
    v_exp_f32 v93, v93
    v_exp_f32 v94, v94
    v_exp_f32 v95, v95
    v_exp_f32 v96, v96
    v_exp_f32 v97, v97
    v_exp_f32 v98, v98
    v_exp_f32 v99, v99
    v_exp_f32 v100, v100
    v_exp_f32 v101, v101
    v_exp_f32 v102, v102
    v_exp_f32 v103, v103
    v_exp_f32 v104, v104
    v_exp_f32 v105, v105
    v_exp_f32 v106, v106
    v_exp_f32 v107, v107
    v_exp_f32 v108, v108
    v_exp_f32 v109, v109
    v_exp_f32 v110, v110
    v_exp_f32 v111, v111
    s_nop 0
    v_cvt_pk_bf16_f32 v120, v80, v81
    v_cvt_pk_bf16_f32 v121, v82, v83
    v_cvt_pk_bf16_f32 v122, v84, v85
    v_cvt_pk_bf16_f32 v123, v86, v87
    v_cvt_pk_bf16_f32 v124, v88, v89
    v_cvt_pk_bf16_f32 v125, v90, v91
    v_cvt_pk_bf16_f32 v126, v92, v93
    v_cvt_pk_bf16_f32 v127, v94, v95
    v_cvt_pk_bf16_f32 v128, v96, v97
    v_cvt_pk_bf16_f32 v129, v98, v99
    v_cvt_pk_bf16_f32 v130, v100, v101
    v_cvt_pk_bf16_f32 v131, v102, v103
    v_cvt_pk_bf16_f32 v132, v104, v105
    v_cvt_pk_bf16_f32 v133, v106, v107
    v_cvt_pk_bf16_f32 v134, v108, v109
    v_cvt_pk_bf16_f32 v135, v110, v111
    s_nop 0
    v_mfma_f32_16x16x32_bf16 v[48:51], a[128:131], v[120:123], 0
    v_add_f32 v173, v80, v81
    v_mfma_f32_16x16x32_bf16 v[52:55], a[132:135], v[120:123], 0
    v_add_f32 v30, v82, v83
    v_mfma_f32_16x16x32_bf16 v[56:59], a[136:139], v[120:123], 0
    v_add_f32 v173, v173, v84
    v_mfma_f32_16x16x32_bf16 v[60:63], a[140:143], v[120:123], 0
    v_add_f32 v30, v30, v85
    v_mfma_f32_16x16x32_bf16 v[64:67], a[144:147], v[120:123], 0
    v_add_f32 v173, v173, v86
    v_mfma_f32_16x16x32_bf16 v[68:71], a[148:151], v[120:123], 0
    v_add_f32 v30, v30, v87
    v_mfma_f32_16x16x32_bf16 v[72:75], a[152:155], v[120:123], 0
    v_add_f32 v173, v173, v88
    v_mfma_f32_16x16x32_bf16 v[76:79], a[156:159], v[120:123], 0
    v_add_f32 v30, v30, v89
    v_mfma_f32_16x16x32_bf16 v[48:51], a[160:163], v[124:127], v[48:51]
    v_add_f32 v173, v173, v90
    v_mfma_f32_16x16x32_bf16 v[52:55], a[164:167], v[124:127], v[52:55]
    v_add_f32 v30, v30, v91
    v_mfma_f32_16x16x32_bf16 v[56:59], a[168:171], v[124:127], v[56:59]
    v_add_f32 v173, v173, v92
    v_mfma_f32_16x16x32_bf16 v[60:63], a[172:175], v[124:127], v[60:63]
    v_add_f32 v30, v30, v93
    v_mfma_f32_16x16x32_bf16 v[64:67], a[176:179], v[124:127], v[64:67]
    v_add_f32 v173, v173, v94
    v_mfma_f32_16x16x32_bf16 v[68:71], a[180:183], v[124:127], v[68:71]
    v_add_f32 v30, v30, v95
    v_mfma_f32_16x16x32_bf16 v[72:75], a[184:187], v[124:127], v[72:75]
    v_add_f32 v173, v173, v96
    v_mfma_f32_16x16x32_bf16 v[76:79], a[188:191], v[124:127], v[76:79]
    v_add_f32 v30, v30, v97
    v_mfma_f32_16x16x32_bf16 v[48:51], a[192:195], v[128:131], v[48:51]
    v_add_f32 v173, v173, v98
    v_mfma_f32_16x16x32_bf16 v[52:55], a[196:199], v[128:131], v[52:55]
    v_add_f32 v30, v30, v99
    v_mfma_f32_16x16x32_bf16 v[56:59], a[200:203], v[128:131], v[56:59]
    v_add_f32 v173, v173, v100
    v_mfma_f32_16x16x32_bf16 v[60:63], a[204:207], v[128:131], v[60:63]
    v_add_f32 v30, v30, v101
    v_mfma_f32_16x16x32_bf16 v[64:67], a[208:211], v[128:131], v[64:67]
    v_add_f32 v173, v173, v102
    v_mfma_f32_16x16x32_bf16 v[68:71], a[212:215], v[128:131], v[68:71]
    v_add_f32 v30, v30, v103
    v_mfma_f32_16x16x32_bf16 v[72:75], a[216:219], v[128:131], v[72:75]
    v_add_f32 v173, v173, v104
    v_mfma_f32_16x16x32_bf16 v[76:79], a[220:223], v[128:131], v[76:79]
    v_add_f32 v30, v30, v105
    v_mfma_f32_16x16x32_bf16 v[48:51], a[224:227], v[132:135], v[48:51]
    v_add_f32 v173, v173, v106
    v_mfma_f32_16x16x32_bf16 v[52:55], a[228:231], v[132:135], v[52:55]
    v_add_f32 v30, v30, v107
    v_mfma_f32_16x16x32_bf16 v[56:59], a[232:235], v[132:135], v[56:59]
    v_add_f32 v173, v173, v108
    v_mfma_f32_16x16x32_bf16 v[60:63], a[236:239], v[132:135], v[60:63]
    v_add_f32 v30, v30, v109
    v_mfma_f32_16x16x32_bf16 v[64:67], a[240:243], v[132:135], v[64:67]
    v_add_f32 v173, v173, v110
    v_mfma_f32_16x16x32_bf16 v[68:71], a[244:247], v[132:135], v[68:71]
    v_add_f32 v30, v30, v111
    v_mfma_f32_16x16x32_bf16 v[72:75], a[248:251], v[132:135], v[72:75]
    v_add_f32 v173, v173, v30
    v_mfma_f32_16x16x32_bf16 v[76:79], a[252:255], v[132:135], v[76:79]
    s_mov_b32 s73, 10
    s_cmp_eq_u32 s66, 2
    s_cbranch_scc0 L_loop
    v_mov_b32 v177, v173
    v_mov_b32 v28, v177
    s_nop 1
    v_permlane32_swap_b32 v177, v28
    s_nop 0
    v_add_f32 v177, v177, v28
    v_mov_b32 v28, v177
    s_nop 1
    v_permlane16_swap_b32 v177, v28
    s_nop 0
    v_add_f32 v177, v177, v28
    v_mov_b32 v176, v174
    s_mov_b64 exec, 0xff
    ds_write_b64 v229, v[176:177] offset:27392
    s_mov_b64 exec, -1
    s_branch L_done
L_loop:
    s_waitcnt vmcnt(12) lgkmcnt(0)
    ds_read_b128 v[140:143], v14 offset:0
    ds_read_b128 v[144:147], v15 offset:0
    ds_read_b128 v[148:151], v16 offset:0
    ds_read_b128 v[152:155], v17 offset:0
    s_cmp_lg_u32 s66, 0
    s_cbranch_scc1 L_st2_0
    s_cmp_ge_u32 s64, 320
    s_cbranch_scc1 L_st1_0
    s_sub_u32 s18, s64, s19
    s_mov_b32 s19, s64
    s_add_u32 s65, s64, s3
    s_and_b32 s65, s65, 511
    s_lshl_b32 s65, s65, 12
    s_add_u32 s65, s65, s63
    s_waitcnt lgkmcnt(0)
    s_add_u32 m0, s58, 0
    s_add_u32 s62, s65, 0
    buffer_load_dwordx4 v2, s[40:43], s62 offen offset:0 nt lds
    buffer_load_dwordx4 v3, s[40:43], s62 offen offset:1024 nt lds
    buffer_load_dwordx4 v4, s[40:43], s62 offen offset:2048 nt lds
    buffer_load_dwordx4 v5, s[40:43], s62 offen offset:3072 nt lds
    s_branch L_ka_0
L_st2_0:
    s_mov_b32 s66, 1
L_st1_0:
    s_add_u32 s66, s66, 1
    s_waitcnt lgkmcnt(0)
    s_or_b32 s20, s20, 1
    s_add_u32 m0, s21, 0
    s_add_u32 s62, s60, 0
    buffer_load_dwordx4 v10, s[52:55], s62 offen nt lds
    s_add_u32 m0, s21, 1024
    s_add_u32 s62, s60, 4096
    buffer_load_dwordx4 v11, s[52:55], s62 offen nt lds
    s_add_u32 m0, s21, 2048
    s_add_u32 s62, s60, 8192
    buffer_load_dwordx4 v12, s[52:55], s62 offen nt lds
    s_add_u32 m0, s21, 3072
    s_add_u32 s62, s60, 12288
    buffer_load_dwordx4 v13, s[52:55], s62 offen nt lds
L_ka_0:
    v_mfma_f32_16x16x32_bf16 v[80:83], v[140:143], v[32:35], 0
    v_mfma_f32_16x16x32_bf16 v[80:83], v[144:147], v[36:39], v[80:83]
    v_mfma_f32_16x16x32_bf16 v[80:83], v[148:151], v[40:43], v[80:83]
    v_mfma_f32_16x16x32_bf16 v[80:83], v[152:155], v[44:47], v[80:83]
    s_nop 7
    v_max3_f32 v29, v80, v81, v82
    v_max_f32 v29, v29, v83
    v_mov_b32 v28, v29
    s_nop 1
    v_permlane32_swap_b32 v29, v28
    s_nop 0
    v_max_f32 v29, v29, v28
    v_mov_b32 v28, v29
    s_nop 1
    v_permlane16_swap_b32 v29, v28
    s_nop 0
    v_max_f32 v29, v29, v28
    v_max_f32 v172, v172, v29
    v_mul_f32 v29, s68, v172
    v_sub_f32 v175, v174, v29
    v_mov_b32 v174, v29
    v_exp_f32 v175, v175
    v_fma_f32 v80, v80, s68, -v174
    v_fma_f32 v81, v81, s68, -v174
    v_fma_f32 v82, v82, s68, -v174
    v_fma_f32 v83, v83, s68, -v174
    v_exp_f32 v80, v80
    v_exp_f32 v81, v81
    v_exp_f32 v82, v82
    v_exp_f32 v83, v83
    v_mov_b32 v178, v175
    v_mov_b32 v179, v175
    v_pk_mul_f32 v[48:49], v[48:49], v[178:179]
    v_pk_mul_f32 v[50:51], v[50:51], v[178:179]
    v_pk_mul_f32 v[52:53], v[52:53], v[178:179]
    v_pk_mul_f32 v[54:55], v[54:55], v[178:179]
    v_pk_mul_f32 v[56:57], v[56:57], v[178:179]
    v_pk_mul_f32 v[58:59], v[58:59], v[178:179]
    v_pk_mul_f32 v[60:61], v[60:61], v[178:179]
    v_pk_mul_f32 v[62:63], v[62:63], v[178:179]
    v_pk_mul_f32 v[64:65], v[64:65], v[178:179]
    v_pk_mul_f32 v[66:67], v[66:67], v[178:179]
    v_pk_mul_f32 v[68:69], v[68:69], v[178:179]
    v_pk_mul_f32 v[70:71], v[70:71], v[178:179]
    v_pk_mul_f32 v[72:73], v[72:73], v[178:179]
    v_pk_mul_f32 v[74:75], v[74:75], v[178:179]
    v_pk_mul_f32 v[76:77], v[76:77], v[178:179]
    v_pk_mul_f32 v[78:79], v[78:79], v[178:179]
    v_add_f32 v28, v80, v81
    v_add_f32 v29, v82, v83
    v_add_f32 v28, v28, v29
    v_fma_f32 v173, v173, v175, v28
    v_cvt_pk_bf16_f32 v120, v80, v81
    v_cvt_pk_bf16_f32 v121, v82, v83
    v_mov_b32 v141, v173
    v_mov_b32 v28, v141
    s_nop 1
    v_permlane32_swap_b32 v141, v28
    s_nop 0
    v_add_f32 v141, v141, v28
    v_mov_b32 v28, v141
    s_nop 1
    v_permlane16_swap_b32 v141, v28
    s_nop 0
    v_add_f32 v141, v141, v28
    v_mov_b32 v140, v174
    s_mov_b64 exec, 0xff
    ds_write_b64 v229, v[140:141] offset:27392
    s_mov_b64 exec, -1
    s_waitcnt vmcnt(12)
L_lf_0:
    ds_read_b64_tr_b16 v[156:157], v18 offset:4096
    ds_read_b64_tr_b16 v[158:159], v19 offset:4096
    ds_read_b64_tr_b16 v[160:161], v20 offset:4096
    ds_read_b64_tr_b16 v[162:163], v21 offset:4096
    ds_read_b64_tr_b16 v[164:165], v22 offset:4096
    ds_read_b64_tr_b16 v[166:167], v23 offset:4096
    ds_read_b64_tr_b16 v[168:169], v24 offset:4096
    ds_read_b64_tr_b16 v[170:171], v25 offset:4096
    s_waitcnt lgkmcnt(0)
    s_cmp_lg_u32 s66, 0
    s_cbranch_scc1 L_vw_0
    s_add_u32 m0, s58, 4096
    s_add_u32 s62, s65, 0
    buffer_load_dwordx4 v6, s[44:47], s62 offen offset:0 nt lds
    buffer_load_dwordx4 v7, s[44:47], s62 offen offset:1024 nt lds
    buffer_load_dwordx4 v6, s[44:47], s62 offen offset:2048 nt lds
    buffer_load_dwordx4 v7, s[44:47], s62 offen offset:3072 nt lds
    s_mov_b32 s64, 1
    s_atomic_add s64, s[70:71], 0x0 glc
    v_mfma_f32_16x16x16_bf16 v[48:51], v[156:157], v[120:121], v[48:51]
    v_mfma_f32_16x16x16_bf16 v[52:55], v[158:159], v[120:121], v[52:55]
    v_mfma_f32_16x16x16_bf16 v[56:59], v[160:161], v[120:121], v[56:59]
    v_mfma_f32_16x16x16_bf16 v[60:63], v[162:163], v[120:121], v[60:63]
    v_mfma_f32_16x16x16_bf16 v[64:67], v[164:165], v[120:121], v[64:67]
    v_mfma_f32_16x16x16_bf16 v[68:71], v[166:167], v[120:121], v[68:71]
    v_mfma_f32_16x16x16_bf16 v[72:75], v[168:169], v[120:121], v[72:75]
    v_mfma_f32_16x16x16_bf16 v[76:79], v[170:171], v[120:121], v[76:79]
    s_branch L_va_0
L_vw_0:
    v_mfma_f32_16x16x16_bf16 v[48:51], v[156:157], v[120:121], v[48:51]
    v_mfma_f32_16x16x16_bf16 v[52:55], v[158:159], v[120:121], v[52:55]
    v_mfma_f32_16x16x16_bf16 v[56:59], v[160:161], v[120:121], v[56:59]
    v_mfma_f32_16x16x16_bf16 v[60:63], v[162:163], v[120:121], v[60:63]
    v_mfma_f32_16x16x16_bf16 v[64:67], v[164:165], v[120:121], v[64:67]
    v_mfma_f32_16x16x16_bf16 v[68:71], v[166:167], v[120:121], v[68:71]
    v_mfma_f32_16x16x16_bf16 v[72:75], v[168:169], v[120:121], v[72:75]
    v_mfma_f32_16x16x16_bf16 v[76:79], v[170:171], v[120:121], v[76:79]
    s_cmp_eq_u32 s66, 2
    s_cbranch_scc1 L_done_0
    s_or_b32 s20, s20, 2
    s_add_u32 m0, s21, 16384
    s_add_u32 s62, s60, 65536
    buffer_load_dwordx4 v10, s[52:55], s62 offen nt lds
    s_add_u32 m0, s21, 17408
    s_add_u32 s62, s60, 69632
    buffer_load_dwordx4 v11, s[52:55], s62 offen nt lds
    s_add_u32 m0, s21, 18432
    s_add_u32 s62, s60, 73728
    buffer_load_dwordx4 v12, s[52:55], s62 offen nt lds
    s_add_u32 m0, s21, 19456
    s_add_u32 s62, s60, 77824
    buffer_load_dwordx4 v13, s[52:55], s62 offen nt lds
L_va_0:
    s_waitcnt vmcnt(12) lgkmcnt(0)
    ds_read_b128 v[140:143], v14 offset:8192
    ds_read_b128 v[144:147], v15 offset:8192
    ds_read_b128 v[148:151], v16 offset:8192
    ds_read_b128 v[152:155], v17 offset:8192
    s_cmp_lg_u32 s66, 0
    s_cbranch_scc1 L_st2_1
    s_cmp_ge_u32 s64, 320
    s_cbranch_scc1 L_st1_1
    s_sub_u32 s18, s64, s19
    s_mov_b32 s19, s64
    s_add_u32 s65, s64, s3
    s_and_b32 s65, s65, 511
    s_lshl_b32 s65, s65, 12
    s_add_u32 s65, s65, s63
    s_waitcnt lgkmcnt(0)
    s_add_u32 m0, s58, 8192
    s_add_u32 s62, s65, 0
    buffer_load_dwordx4 v2, s[40:43], s62 offen offset:0 nt lds
    buffer_load_dwordx4 v3, s[40:43], s62 offen offset:1024 nt lds
    buffer_load_dwordx4 v4, s[40:43], s62 offen offset:2048 nt lds
    buffer_load_dwordx4 v5, s[40:43], s62 offen offset:3072 nt lds
    s_branch L_ka_1
L_st2_1:
    s_mov_b32 s66, 1
L_st1_1:
    s_add_u32 s66, s66, 1
    s_waitcnt lgkmcnt(0)
    s_or_b32 s20, s20, 4
    s_add_u32 m0, s21, 32768
    s_add_u32 s62, s60, 131072
    buffer_load_dwordx4 v10, s[52:55], s62 offen nt lds
    s_add_u32 m0, s21, 33792
    s_add_u32 s62, s60, 135168
    buffer_load_dwordx4 v11, s[52:55], s62 offen nt lds
    s_add_u32 m0, s21, 34816
    s_add_u32 s62, s60, 139264
    buffer_load_dwordx4 v12, s[52:55], s62 offen nt lds
    s_add_u32 m0, s21, 35840
    s_add_u32 s62, s60, 143360
    buffer_load_dwordx4 v13, s[52:55], s62 offen nt lds
L_ka_1:
    v_mfma_f32_16x16x32_bf16 v[80:83], v[140:143], v[32:35], 0
    v_mfma_f32_16x16x32_bf16 v[80:83], v[144:147], v[36:39], v[80:83]
    v_mfma_f32_16x16x32_bf16 v[80:83], v[148:151], v[40:43], v[80:83]
    v_mfma_f32_16x16x32_bf16 v[80:83], v[152:155], v[44:47], v[80:83]
    s_nop 7
    v_max3_f32 v29, v80, v81, v82
    v_max_f32 v29, v29, v83
    v_mov_b32 v28, v29
    s_nop 1
    v_permlane32_swap_b32 v29, v28
    s_nop 0
    v_max_f32 v29, v29, v28
    v_mov_b32 v28, v29
    s_nop 1
    v_permlane16_swap_b32 v29, v28
    s_nop 0
    v_max_f32 v29, v29, v28
    v_max_f32 v172, v172, v29
    v_mul_f32 v29, s68, v172
    v_sub_f32 v175, v174, v29
    v_mov_b32 v174, v29
    v_exp_f32 v175, v175
    v_fma_f32 v80, v80, s68, -v174
    v_fma_f32 v81, v81, s68, -v174
    v_fma_f32 v82, v82, s68, -v174
    v_fma_f32 v83, v83, s68, -v174
    v_exp_f32 v80, v80
    v_exp_f32 v81, v81
    v_exp_f32 v82, v82
    v_exp_f32 v83, v83
    v_mov_b32 v178, v175
    v_mov_b32 v179, v175
    v_pk_mul_f32 v[48:49], v[48:49], v[178:179]
    v_pk_mul_f32 v[50:51], v[50:51], v[178:179]
    v_pk_mul_f32 v[52:53], v[52:53], v[178:179]
    v_pk_mul_f32 v[54:55], v[54:55], v[178:179]
    v_pk_mul_f32 v[56:57], v[56:57], v[178:179]
    v_pk_mul_f32 v[58:59], v[58:59], v[178:179]
    v_pk_mul_f32 v[60:61], v[60:61], v[178:179]
    v_pk_mul_f32 v[62:63], v[62:63], v[178:179]
    v_pk_mul_f32 v[64:65], v[64:65], v[178:179]
    v_pk_mul_f32 v[66:67], v[66:67], v[178:179]
    v_pk_mul_f32 v[68:69], v[68:69], v[178:179]
    v_pk_mul_f32 v[70:71], v[70:71], v[178:179]
    v_pk_mul_f32 v[72:73], v[72:73], v[178:179]
    v_pk_mul_f32 v[74:75], v[74:75], v[178:179]
    v_pk_mul_f32 v[76:77], v[76:77], v[178:179]
    v_pk_mul_f32 v[78:79], v[78:79], v[178:179]
    v_add_f32 v28, v80, v81
    v_add_f32 v29, v82, v83
    v_add_f32 v28, v28, v29
    v_fma_f32 v173, v173, v175, v28
    v_cvt_pk_bf16_f32 v120, v80, v81
    v_cvt_pk_bf16_f32 v121, v82, v83
    v_mov_b32 v141, v173
    v_mov_b32 v28, v141
    s_nop 1
    v_permlane32_swap_b32 v141, v28
    s_nop 0
    v_add_f32 v141, v141, v28
    v_mov_b32 v28, v141
    s_nop 1
    v_permlane16_swap_b32 v141, v28
    s_nop 0
    v_add_f32 v141, v141, v28
    v_mov_b32 v140, v174
    s_mov_b64 exec, 0xff
    ds_write_b64 v229, v[140:141] offset:27392
    s_mov_b64 exec, -1
    s_waitcnt vmcnt(12)
L_lf_1:
    ds_read_b64_tr_b16 v[156:157], v18 offset:12288
    ds_read_b64_tr_b16 v[158:159], v19 offset:12288
    ds_read_b64_tr_b16 v[160:161], v20 offset:12288
    ds_read_b64_tr_b16 v[162:163], v21 offset:12288
    ds_read_b64_tr_b16 v[164:165], v22 offset:12288
    ds_read_b64_tr_b16 v[166:167], v23 offset:12288
    ds_read_b64_tr_b16 v[168:169], v24 offset:12288
    ds_read_b64_tr_b16 v[170:171], v25 offset:12288
    s_waitcnt lgkmcnt(0)
    s_cmp_lg_u32 s66, 0
    s_cbranch_scc1 L_vw_1
    s_add_u32 m0, s58, 12288
    s_add_u32 s62, s65, 0
    buffer_load_dwordx4 v6, s[44:47], s62 offen offset:0 nt lds
    buffer_load_dwordx4 v7, s[44:47], s62 offen offset:1024 nt lds
    buffer_load_dwordx4 v6, s[44:47], s62 offen offset:2048 nt lds
    buffer_load_dwordx4 v7, s[44:47], s62 offen offset:3072 nt lds
    s_mov_b32 s64, 1
    s_atomic_add s64, s[70:71], 0x0 glc
    v_mfma_f32_16x16x16_bf16 v[48:51], v[156:157], v[120:121], v[48:51]
    v_mfma_f32_16x16x16_bf16 v[52:55], v[158:159], v[120:121], v[52:55]
    v_mfma_f32_16x16x16_bf16 v[56:59], v[160:161], v[120:121], v[56:59]
    v_mfma_f32_16x16x16_bf16 v[60:63], v[162:163], v[120:121], v[60:63]
    v_mfma_f32_16x16x16_bf16 v[64:67], v[164:165], v[120:121], v[64:67]
    v_mfma_f32_16x16x16_bf16 v[68:71], v[166:167], v[120:121], v[68:71]
    v_mfma_f32_16x16x16_bf16 v[72:75], v[168:169], v[120:121], v[72:75]
    v_mfma_f32_16x16x16_bf16 v[76:79], v[170:171], v[120:121], v[76:79]
    s_branch L_va_1
L_vw_1:
    v_mfma_f32_16x16x16_bf16 v[48:51], v[156:157], v[120:121], v[48:51]
    v_mfma_f32_16x16x16_bf16 v[52:55], v[158:159], v[120:121], v[52:55]
    v_mfma_f32_16x16x16_bf16 v[56:59], v[160:161], v[120:121], v[56:59]
    v_mfma_f32_16x16x16_bf16 v[60:63], v[162:163], v[120:121], v[60:63]
    v_mfma_f32_16x16x16_bf16 v[64:67], v[164:165], v[120:121], v[64:67]
    v_mfma_f32_16x16x16_bf16 v[68:71], v[166:167], v[120:121], v[68:71]
    v_mfma_f32_16x16x16_bf16 v[72:75], v[168:169], v[120:121], v[72:75]
    v_mfma_f32_16x16x16_bf16 v[76:79], v[170:171], v[120:121], v[76:79]
    s_cmp_eq_u32 s66, 2
    s_cbranch_scc1 L_done_1
    s_or_b32 s20, s20, 8
    s_add_u32 m0, s21, 49152
    s_add_u32 s62, s60, 196608
    buffer_load_dwordx4 v10, s[52:55], s62 offen nt lds
    s_add_u32 m0, s21, 50176
    s_add_u32 s62, s60, 200704
    buffer_load_dwordx4 v11, s[52:55], s62 offen nt lds
    s_add_u32 m0, s21, 51200
    s_add_u32 s62, s60, 204800
    buffer_load_dwordx4 v12, s[52:55], s62 offen nt lds
    s_add_u32 m0, s21, 52224
    s_add_u32 s62, s60, 208896
    buffer_load_dwordx4 v13, s[52:55], s62 offen nt lds
L_va_1:
    s_branch L_loop
L_done_0:
    s_mov_b32 s65, 1
    s_branch L_done
L_done_1:
    s_mov_b32 s65, 3
L_done:
    s_mov_b64 exec, s[14:15]
    s_nop 0
    ds_write_b128 v228, v[48:51] offset:10496
    ds_write_b128 v228, v[52:55] offset:10560
    ds_write_b128 v228, v[56:59] offset:10624
    ds_write_b128 v228, v[60:63] offset:10688
    ds_write_b128 v228, v[64:67] offset:10752
    ds_write_b128 v228, v[68:71] offset:10816
    ds_write_b128 v228, v[72:75] offset:10880
    ds_write_b128 v228, v[76:79] offset:10944
    s_mov_b64 exec, -1
    s_waitcnt lgkmcnt(0)
    s_barrier
    ds_read_b128 v[80:83], v231 offset:27392
    ds_read_b128 v[84:87], v231 offset:27408
    ds_read_b128 v[184:187], v230 offset:10496
    ds_read_b128 v[188:191], v230 offset:14720
    ds_read_b128 v[192:195], v230 offset:18944
    ds_read_b128 v[196:199], v230 offset:23168
    s_waitcnt lgkmcnt(4)
    v_max3_f32 v172, v80, v82, v84
    v_max_f32 v172, v172, v86
    v_sub_f32 v80, v80, v172
    v_sub_f32 v82, v82, v172
    v_sub_f32 v84, v84, v172
    v_sub_f32 v86, v86, v172
    v_exp_f32 v80, v80
    v_exp_f32 v82, v82
    v_exp_f32 v84, v84
    v_exp_f32 v86, v86
    s_nop 0
    v_mul_f32 v173, v80, v81
    v_fmac_f32 v173, v82, v83
    v_fmac_f32 v173, v84, v85
    v_fmac_f32 v173, v86, v87
    v_rcp_f32 v175, v173
    v_log_f32 v173, v173
    s_waitcnt lgkmcnt(0)
    v_mul_f32 v184, v80, v184
    v_mul_f32 v185, v80, v185
    v_mul_f32 v186, v80, v186
    v_mul_f32 v187, v80, v187
    v_fmac_f32 v184, v82, v188
    v_fmac_f32 v185, v82, v189
    v_fmac_f32 v186, v82, v190
    v_fmac_f32 v187, v82, v191
    v_fmac_f32 v184, v84, v192
    v_fmac_f32 v185, v84, v193
    v_fmac_f32 v186, v84, v194
    v_fmac_f32 v187, v84, v195
    v_fmac_f32 v184, v86, v196
    v_fmac_f32 v185, v86, v197
    v_fmac_f32 v186, v86, v198
    v_fmac_f32 v187, v86, v199
    v_mul_f32 v184, v175, v184
    v_mul_f32 v185, v175, v185
    v_mul_f32 v186, v175, v186
    v_mul_f32 v187, v175, v187
    v_cvt_pk_bf16_f32 v188, v184, v185
    v_cvt_pk_bf16_f32 v189, v186, v187
    v_add_f32 v172, v172, v173
    v_min_u32 v188, -2, v188
    v_min_u32 v189, -2, v189
    v_min_u32 v172, -2, v172
    global_store_dwordx2 v232, v[188:189], s[30:31] sc1
    s_mov_b32 exec_lo, 1
    s_mov_b32 exec_hi, 1
    global_store_dword v233, v172, s[30:31] sc1
    s_mov_b64 exec, -1
    s_bitcmp1_b32 s20, 0
    s_cbranch_scc1 L_wr_0
    s_or_b32 s20, s20, 1
    s_add_u32 m0, s21, 0
    s_add_u32 s62, s60, 0
    buffer_load_dwordx4 v10, s[52:55], s62 offen nt lds
    s_add_u32 m0, s21, 1024
    s_add_u32 s62, s60, 4096
    buffer_load_dwordx4 v11, s[52:55], s62 offen nt lds
    s_add_u32 m0, s21, 2048
    s_add_u32 s62, s60, 8192
    buffer_load_dwordx4 v12, s[52:55], s62 offen nt lds
    s_add_u32 m0, s21, 3072
    s_add_u32 s62, s60, 12288
    buffer_load_dwordx4 v13, s[52:55], s62 offen nt lds
L_wr_0:
    s_bitcmp1_b32 s20, 1
    s_cbranch_scc1 L_wr_1
    s_or_b32 s20, s20, 2
    s_add_u32 m0, s21, 16384
    s_add_u32 s62, s60, 65536
    buffer_load_dwordx4 v10, s[52:55], s62 offen nt lds
    s_add_u32 m0, s21, 17408
    s_add_u32 s62, s60, 69632
    buffer_load_dwordx4 v11, s[52:55], s62 offen nt lds
    s_add_u32 m0, s21, 18432
    s_add_u32 s62, s60, 73728
    buffer_load_dwordx4 v12, s[52:55], s62 offen nt lds
    s_add_u32 m0, s21, 19456
    s_add_u32 s62, s60, 77824
    buffer_load_dwordx4 v13, s[52:55], s62 offen nt lds
L_wr_1:
    s_bitcmp1_b32 s20, 2
    s_cbranch_scc1 L_wr_2
    s_or_b32 s20, s20, 4
    s_add_u32 m0, s21, 32768
    s_add_u32 s62, s60, 131072
    buffer_load_dwordx4 v10, s[52:55], s62 offen nt lds
    s_add_u32 m0, s21, 33792
    s_add_u32 s62, s60, 135168
    buffer_load_dwordx4 v11, s[52:55], s62 offen nt lds
    s_add_u32 m0, s21, 34816
    s_add_u32 s62, s60, 139264
    buffer_load_dwordx4 v12, s[52:55], s62 offen nt lds
    s_add_u32 m0, s21, 35840
    s_add_u32 s62, s60, 143360
    buffer_load_dwordx4 v13, s[52:55], s62 offen nt lds
L_wr_2:
    s_bitcmp1_b32 s20, 3
    s_cbranch_scc1 L_wr_3
    s_or_b32 s20, s20, 8
    s_add_u32 m0, s21, 49152
    s_add_u32 s62, s60, 196608
    buffer_load_dwordx4 v10, s[52:55], s62 offen nt lds
    s_add_u32 m0, s21, 50176
    s_add_u32 s62, s60, 200704
    buffer_load_dwordx4 v11, s[52:55], s62 offen nt lds
    s_add_u32 m0, s21, 51200
    s_add_u32 s62, s60, 204800
    buffer_load_dwordx4 v12, s[52:55], s62 offen nt lds
    s_add_u32 m0, s21, 52224
    s_add_u32 s62, s60, 208896
    buffer_load_dwordx4 v13, s[52:55], s62 offen nt lds
L_wr_3:
    s_waitcnt vmcnt(0)
    global_load_dword v80, v238, s[30:31] offset:0 sc1
    global_load_dword v81, v238, s[30:31] offset:256 sc1
    global_load_dword v82, v238, s[30:31] offset:512 sc1
    global_load_dword v83, v238, s[30:31] offset:768 sc1
    global_load_dword v84, v238, s[30:31] offset:1024 sc1
    global_load_dword v85, v238, s[30:31] offset:1280 sc1
    global_load_dword v86, v238, s[30:31] offset:1536 sc1
    global_load_dword v87, v238, s[30:31] offset:1792 sc1
    global_load_dwordx4 v[88:91], v234, s[30:31] offset:0 sc1
    global_load_dwordx4 v[92:95], v234, s[30:31] offset:16 sc1
    s_waitcnt vmcnt(10)
    s_barrier
    ds_read_b64_tr_b16 a[0:1], v246 offset:0
    ds_read_b64_tr_b16 a[2:3], v246 offset:8192
    ds_read_b64_tr_b16 a[4:5], v247 offset:0
    ds_read_b64_tr_b16 a[6:7], v247 offset:8192
    ds_read_b64_tr_b16 a[8:9], v248 offset:0
    ds_read_b64_tr_b16 a[10:11], v248 offset:8192
    ds_read_b64_tr_b16 a[12:13], v249 offset:0
    ds_read_b64_tr_b16 a[14:15], v249 offset:8192
    ds_read_b64_tr_b16 a[16:17], v246 offset:16384
    ds_read_b64_tr_b16 a[18:19], v246 offset:24576
    ds_read_b64_tr_b16 a[20:21], v247 offset:16384
    ds_read_b64_tr_b16 a[22:23], v247 offset:24576
    ds_read_b64_tr_b16 a[24:25], v248 offset:16384
    ds_read_b64_tr_b16 a[26:27], v248 offset:24576
    ds_read_b64_tr_b16 a[28:29], v249 offset:16384
    ds_read_b64_tr_b16 a[30:31], v249 offset:24576
    ds_read_b64_tr_b16 a[32:33], v246 offset:32768
    ds_read_b64_tr_b16 a[34:35], v246 offset:40960
    ds_read_b64_tr_b16 a[36:37], v247 offset:32768
    ds_read_b64_tr_b16 a[38:39], v247 offset:40960
    ds_read_b64_tr_b16 a[40:41], v248 offset:32768
    ds_read_b64_tr_b16 a[42:43], v248 offset:40960
    ds_read_b64_tr_b16 a[44:45], v249 offset:32768
    ds_read_b64_tr_b16 a[46:47], v249 offset:40960
    ds_read_b64_tr_b16 a[48:49], v246 offset:49152
    ds_read_b64_tr_b16 a[50:51], v246 offset:57344
    ds_read_b64_tr_b16 a[52:53], v247 offset:49152
    ds_read_b64_tr_b16 a[54:55], v247 offset:57344
    ds_read_b64_tr_b16 a[56:57], v248 offset:49152
    ds_read_b64_tr_b16 a[58:59], v248 offset:57344
    ds_read_b64_tr_b16 a[60:61], v249 offset:49152
    ds_read_b64_tr_b16 a[62:63], v249 offset:57344
    s_mov_b32 s67, 0
L_g3:
    s_waitcnt vmcnt(0)
    v_max3_u32 v28, v80, v81, v82
    v_max3_u32 v28, v28, v83, v84
    v_max3_u32 v28, v28, v85, v86
    v_max3_u32 v28, v28, v87, v88
    v_max3_u32 v28, v28, v89, v90
    v_max3_u32 v28, v28, v91, v92
    v_max3_u32 v28, v28, v93, v94
    v_max_u32 v28, v28, v95
    v_cmp_eq_u32 vcc, -1, v28
    v_max3_f32 v172, v88, v89, v90
    v_max3_f32 v172, v172, v91, v92
    v_max3_f32 v172, v172, v93, v94
    v_max_f32 v172, v172, v95
    s_add_u32 s67, s67, 1
    s_cbranch_vccz L_g3ok
    s_cmp_gt_u32 s67, 200000
    s_cbranch_scc1 L_g3ok
    v_cmp_eq_u32 s[4:5], -1, v80
    v_cmp_eq_u32 s[6:7], -1, v81
    v_cmp_eq_u32 s[8:9], -1, v82
    v_cmp_eq_u32 s[10:11], -1, v83
    s_nop 0
    s_mov_b64 exec, s[4:5]
    s_cbranch_execz L_g3s_0
    global_load_dword v80, v238, s[30:31] offset:0 sc1
L_g3s_0:
    s_mov_b64 exec, s[6:7]
    s_cbranch_execz L_g3s_1
    global_load_dword v81, v238, s[30:31] offset:256 sc1
L_g3s_1:
    s_mov_b64 exec, s[8:9]
    s_cbranch_execz L_g3s_2
    global_load_dword v82, v238, s[30:31] offset:512 sc1
L_g3s_2:
    s_mov_b64 exec, s[10:11]
    s_cbranch_execz L_g3s_3
    global_load_dword v83, v238, s[30:31] offset:768 sc1
L_g3s_3:
    s_mov_b64 exec, -1
    v_cmp_eq_u32 s[4:5], -1, v84
    v_cmp_eq_u32 s[6:7], -1, v85
    v_cmp_eq_u32 s[8:9], -1, v86
    v_cmp_eq_u32 s[10:11], -1, v87
    s_nop 0
    s_mov_b64 exec, s[4:5]
    s_cbranch_execz L_g3s_4
    global_load_dword v84, v238, s[30:31] offset:1024 sc1
L_g3s_4:
    s_mov_b64 exec, s[6:7]
    s_cbranch_execz L_g3s_5
    global_load_dword v85, v238, s[30:31] offset:1280 sc1
L_g3s_5:
    s_mov_b64 exec, s[8:9]
    s_cbranch_execz L_g3s_6
    global_load_dword v86, v238, s[30:31] offset:1536 sc1
L_g3s_6:
    s_mov_b64 exec, s[10:11]
    s_cbranch_execz L_g3s_7
    global_load_dword v87, v238, s[30:31] offset:1792 sc1
L_g3s_7:
    s_mov_b64 exec, -1
    global_load_dwordx4 v[88:91], v234, s[30:31] offset:0 sc1
    global_load_dwordx4 v[92:95], v234, s[30:31] offset:16 sc1
    s_branch L_g3
L_g3ok:
    v_sub_f32 v48, v88, v172
    v_sub_f32 v49, v89, v172
    v_sub_f32 v50, v90, v172
    v_sub_f32 v51, v91, v172
    v_sub_f32 v52, v92, v172
    v_sub_f32 v53, v93, v172
    v_sub_f32 v54, v94, v172
    v_sub_f32 v55, v95, v172
    v_exp_f32 v48, v48
    v_exp_f32 v49, v49
    v_exp_f32 v50, v50
    v_exp_f32 v51, v51
    v_exp_f32 v52, v52
    v_exp_f32 v53, v53
    v_exp_f32 v54, v54
    v_exp_f32 v55, v55
    v_lshlrev_b32 v56, 16, v80
    v_and_b32 v57, s72, v80
    v_lshlrev_b32 v58, 16, v81
    v_and_b32 v59, s72, v81
    v_lshlrev_b32 v60, 16, v82
    v_and_b32 v61, s72, v82
    v_lshlrev_b32 v62, 16, v83
    v_and_b32 v63, s72, v83
    v_lshlrev_b32 v64, 16, v84
    v_and_b32 v65, s72, v84
    v_lshlrev_b32 v66, 16, v85
    v_and_b32 v67, s72, v85
    v_lshlrev_b32 v68, 16, v86
    v_and_b32 v69, s72, v86
    v_lshlrev_b32 v70, 16, v87
    v_and_b32 v71, s72, v87
    v_add_f32 v173, v48, v49
    v_add_f32 v30, v50, v51
    v_add_f32 v31, v52, v53
    v_add_f32 v172, v54, v55
    v_add_f32 v173, v173, v30
    v_add_f32 v172, v172, v31
    v_add_f32 v173, v173, v172
    v_rcp_f32 v173, v173
    v_mul_f32 v28, v48, v56
    v_mul_f32 v29, v48, v57
    v_fmac_f32 v28, v49, v58
    v_fmac_f32 v29, v49, v59
    v_fmac_f32 v28, v50, v60
    v_fmac_f32 v29, v50, v61
    v_fmac_f32 v28, v51, v62
    v_fmac_f32 v29, v51, v63
    v_fmac_f32 v28, v52, v64
    v_fmac_f32 v29, v52, v65
    v_fmac_f32 v28, v53, v66
    v_fmac_f32 v29, v53, v67
    v_fmac_f32 v28, v54, v68
    v_fmac_f32 v29, v54, v69
    v_fmac_f32 v28, v55, v70
    v_fmac_f32 v29, v55, v71
    v_mul_f32 v28, v28, v173
    v_mul_f32 v29, v29, v173
    v_cvt_pk_bf16_f32 v28, v28, v29
    ds_write_b32 v254, v28 offset:27648
    s_waitcnt lgkmcnt(0)
    s_barrier
    ds_read_b64 v[32:33], v235 offset:27648
    ds_read_b64 v[34:35], v235 offset:27680
    ds_read_b64 v[36:37], v235 offset:27712
    ds_read_b64 v[38:39], v235 offset:27744
    ds_read_b64 v[40:41], v235 offset:27776
    ds_read_b64 v[42:43], v235 offset:27808
    ds_read_b64 v[44:45], v235 offset:27840
    ds_read_b64 v[46:47], v235 offset:27872
    s_waitcnt lgkmcnt(6)
    v_mfma_f32_16x16x32_bf16 v[140:143], a[0:3], v[32:35], 0
    v_mfma_f32_16x16x32_bf16 v[144:147], a[4:7], v[32:35], 0
    v_mfma_f32_16x16x32_bf16 v[148:151], a[8:11], v[32:35], 0
    v_mfma_f32_16x16x32_bf16 v[152:155], a[12:15], v[32:35], 0
    s_waitcnt lgkmcnt(4)
    v_mfma_f32_16x16x32_bf16 v[140:143], a[16:19], v[36:39], v[140:143]
    v_mfma_f32_16x16x32_bf16 v[144:147], a[20:23], v[36:39], v[144:147]
    v_mfma_f32_16x16x32_bf16 v[148:151], a[24:27], v[36:39], v[148:151]
    v_mfma_f32_16x16x32_bf16 v[152:155], a[28:31], v[36:39], v[152:155]
    s_waitcnt lgkmcnt(2)
    v_mfma_f32_16x16x32_bf16 v[140:143], a[32:35], v[40:43], v[140:143]
    v_mfma_f32_16x16x32_bf16 v[144:147], a[36:39], v[40:43], v[144:147]
    v_mfma_f32_16x16x32_bf16 v[148:151], a[40:43], v[40:43], v[148:151]
    v_mfma_f32_16x16x32_bf16 v[152:155], a[44:47], v[40:43], v[152:155]
    s_waitcnt lgkmcnt(0)
    v_mfma_f32_16x16x32_bf16 v[140:143], a[48:51], v[44:47], v[140:143]
    v_mfma_f32_16x16x32_bf16 v[144:147], a[52:55], v[44:47], v[144:147]
    v_mfma_f32_16x16x32_bf16 v[148:151], a[56:59], v[44:47], v[148:151]
    v_mfma_f32_16x16x32_bf16 v[152:155], a[60:63], v[44:47], v[152:155]
    v_sub_f32 v175, 1.0, v216
    s_mov_b32 s67, 0
    s_nop 2
    s_mov_b64 exec, s[16:17]
    v_min_u32 v140, -2, v140
    v_min_u32 v141, -2, v141
    v_min_u32 v142, -2, v142
    v_min_u32 v143, -2, v143
    global_store_dwordx4 v236, v[140:143], s[30:31] offset:0 sc1
    v_min_u32 v144, -2, v144
    v_min_u32 v145, -2, v145
    v_min_u32 v146, -2, v146
    v_min_u32 v147, -2, v147
    global_store_dwordx4 v236, v[144:147], s[30:31] offset:256 sc1
    v_min_u32 v148, -2, v148
    v_min_u32 v149, -2, v149
    v_min_u32 v150, -2, v150
    v_min_u32 v151, -2, v151
    global_store_dwordx4 v236, v[148:151], s[30:31] offset:512 sc1
    v_min_u32 v152, -2, v152
    v_min_u32 v153, -2, v153
    v_min_u32 v154, -2, v154
    v_min_u32 v155, -2, v155
    global_store_dwordx4 v236, v[152:155], s[30:31] offset:768 sc1
    s_mov_b64 exec, -1
    s_cmp_lg_u32 s32, 0
    s_cbranch_scc1 L_fin
    s_waitcnt vmcnt(0)
    global_load_dwordx4 v[184:187], v250, s[30:31] sc1
    global_load_dwordx4 v[188:191], v251, s[30:31] sc1
    global_load_dwordx4 v[192:195], v252, s[30:31] sc1
    global_load_dwordx4 v[196:199], v253, s[30:31] sc1
L_g4:
    s_waitcnt vmcnt(0)
    v_max3_u32 v28, v184, v185, v186
    v_max3_u32 v29, v188, v189, v190
    v_max3_u32 v30, v192, v193, v194
    v_max3_u32 v31, v196, v197, v198
    v_max_u32 v28, v28, v187
    v_max_u32 v29, v29, v191
    v_max_u32 v30, v30, v195
    v_max_u32 v31, v31, v199
    v_cmp_eq_u32 s[4:5], -1, v28
    v_cmp_eq_u32 s[6:7], -1, v29
    v_cmp_eq_u32 s[8:9], -1, v30
    v_cmp_eq_u32 s[10:11], -1, v31
    v_add_f32 v156, v184, v188
    v_add_f32 v160, v192, v196
    v_add_f32 v157, v185, v189
    v_add_f32 v161, v193, v197
    v_add_f32 v158, v186, v190
    v_add_f32 v162, v194, v198
    v_add_f32 v159, v187, v191
    v_add_f32 v163, v195, v199
    s_or_b64 s[12:13], s[4:5], s[6:7]
    s_or_b64 vcc, s[8:9], s[10:11]
    s_or_b64 vcc, vcc, s[12:13]
    s_cbranch_scc0 L_g4d
    s_add_u32 s67, s67, 1
    s_cmp_gt_u32 s67, 200000
    s_cbranch_scc1 L_g4d
    s_mov_b64 exec, s[4:5]
    s_cbranch_execz L_g4s_0
    global_load_dwordx4 v[184:187], v250, s[30:31] sc1
L_g4s_0:
    s_mov_b64 exec, s[6:7]
    s_cbranch_execz L_g4s_1
    global_load_dwordx4 v[188:191], v251, s[30:31] sc1
L_g4s_1:
    s_mov_b64 exec, s[8:9]
    s_cbranch_execz L_g4s_2
    global_load_dwordx4 v[192:195], v252, s[30:31] sc1
L_g4s_2:
    s_mov_b64 exec, s[10:11]
    s_cbranch_execz L_g4s_3
    global_load_dwordx4 v[196:199], v253, s[30:31] sc1
L_g4s_3:
    s_mov_b64 exec, -1
    s_branch L_g4
L_g4d:
    v_mul_f32 v156, v156, v216
    v_mul_f32 v157, v157, v216
    v_mul_f32 v158, v158, v216
    v_mul_f32 v159, v159, v216
    v_fmac_f32 v156, v160, v175
    v_fmac_f32 v157, v161, v175
    v_fmac_f32 v158, v162, v175
    v_fmac_f32 v159, v163, v175
    s_nop 0
    v_mov_b32_dpp v160, v156 row_ror:8 row_mask:0xf bank_mask:0xf
    v_mov_b32_dpp v161, v157 row_ror:8 row_mask:0xf bank_mask:0xf
    v_mov_b32_dpp v162, v158 row_ror:8 row_mask:0xf bank_mask:0xf
    v_mov_b32_dpp v163, v159 row_ror:8 row_mask:0xf bank_mask:0xf
    v_add_f32 v156, v156, v160
    v_add_f32 v157, v157, v161
    v_add_f32 v158, v158, v162
    v_add_f32 v159, v159, v163
    s_nop 0
    v_mov_b32_dpp v160, v156 row_ror:4 row_mask:0xf bank_mask:0xf
    v_mov_b32_dpp v161, v157 row_ror:4 row_mask:0xf bank_mask:0xf
    v_mov_b32_dpp v162, v158 row_ror:4 row_mask:0xf bank_mask:0xf
    v_mov_b32_dpp v163, v159 row_ror:4 row_mask:0xf bank_mask:0xf
    v_add_f32 v156, v156, v160
    v_add_f32 v157, v157, v161
    v_add_f32 v158, v158, v162
    v_add_f32 v159, v159, v163
    v_mov_b32 v160, v156
    v_mov_b32 v161, v157
    v_mov_b32 v162, v158
    v_mov_b32 v163, v159
    s_nop 1
    v_permlane32_swap_b32 v156, v160
    v_permlane32_swap_b32 v157, v161
    v_permlane32_swap_b32 v158, v162
    v_permlane32_swap_b32 v159, v163
    s_nop 0
    v_add_f32 v156, v156, v160
    v_add_f32 v157, v157, v161
    v_add_f32 v158, v158, v162
    v_add_f32 v159, v159, v163
    v_mov_b32 v160, v156
    v_mov_b32 v161, v157
    v_mov_b32 v162, v158
    v_mov_b32 v163, v159
    s_nop 1
    v_permlane16_swap_b32 v156, v160
    v_permlane16_swap_b32 v157, v161
    v_permlane16_swap_b32 v158, v162
    v_permlane16_swap_b32 v159, v163
    s_nop 0
    v_add_f32 v156, v156, v160
    v_add_f32 v157, v157, v161
    v_add_f32 v158, v158, v162
    v_add_f32 v159, v159, v163
    v_cvt_pk_bf16_f32 v160, v156, v157
    v_cvt_pk_bf16_f32 v161, v158, v159
L_g4ok:
    s_mov_b64 exec, 0xf
    global_store_dwordx2 v237, v[160:161], s[26:27] sc0 sc1
    s_mov_b64 exec, -1
L_fin:
L_end:
s_endpgm
.section .rodata,"a"
.p2align 6
.amdhsa_kernel gated_mix__gqa_block_cached__gqa_block_cached__decode_kernel
  .amdhsa_next_free_vgpr 512
  .amdhsa_next_free_sgpr 102
  .amdhsa_accum_offset 256
  .amdhsa_group_segment_fixed_size 0
  .amdhsa_kernarg_size 112
  .amdhsa_user_sgpr_count 2
  .amdhsa_user_sgpr_kernarg_segment_ptr 1
  .amdhsa_system_sgpr_workgroup_id_x 1
.end_amdhsa_kernel
```
